```python
import torch

def _softmax(x, axis=-1):
    return torch.softmax(x, dim=axis)
def _gelu(x):
    return torch.nn.functional.gelu(x, approximate="tanh")
def _silu(x):
    return torch.nn.functional.silu(x)
def _sigmoid(x):
    return torch.sigmoid(x)
def _layernorm(x, axis=-1, eps=1e-5):
    m = x.mean(dim=axis, keepdim=True)
    v = x.var(dim=axis, keepdim=True, unbiased=False)
    return (x - m) / torch.sqrt(v + eps)
def _scatter_add(tgt, idx, src, axis=0):
    return tgt.clone().index_add_(axis, idx, src)
def _segment_sum(src, seg, n):
    out = torch.zeros((n,) + src.shape[1:], dtype=src.dtype)
    return out.index_add_(0, seg, src)
def _pad(x, pw):
    flat = tuple(v for pair in reversed(pw) for v in pair)
    return torch.nn.functional.pad(x, flat)

kernel_name = 'concat_heads__mha_block_cached__sliding_block_cached__decode'

def setup_inputs():

    _w = (lambda a: (lambda t: t.to(torch.bfloat16) if t.is_floating_point() else t)(torch.as_tensor(a)))
    def _A_setup():
        B, Sq, D = 4, 1, 512
        H, Sk, Dh = 32, 4096, 128
        return {
            "x": _w((lambda *s: torch.randn(*s, dtype=torch.bfloat16) * 0.8)(B, Sq, D)),
            "k_cache": _w((lambda *s: torch.randn(*s, dtype=torch.bfloat16) * 1.6)(B, H, Sk, Dh)),
            "v_cache": _w((lambda *s: torch.randn(*s, dtype=torch.bfloat16) * 0.2)(B, H, Sk, Dh)),
            "wq": _w((lambda *s: torch.randn(*s, dtype=torch.bfloat16) * 1.6)(D, H * Dh) * (D ** -0.5)),
            "wo": _w((lambda *s: torch.randn(*s, dtype=torch.bfloat16) * 0.2)(H * Dh, D) * ((H * Dh) ** -0.5)),
        }
    _A_in = _A_setup()

    def _B_setup():
        B, Sq, D = 4, 1, 512
        Hq, Hkv, Sk, Dh = 32, 8, 4096, 128
        assert Hq % Hkv == 0, (Hq, Hkv)
        return {
            "x": _w((lambda *s: torch.randn(*s, dtype=torch.bfloat16) * 0.8)(B, Sq, D)),
            "k_cache": _w((lambda *s: torch.randn(*s, dtype=torch.bfloat16) * 1.6)(B, Hkv, Sk, Dh)),
            "v_cache": _w((lambda *s: torch.randn(*s, dtype=torch.bfloat16) * 0.2)(B, Hkv, Sk, Dh)),
            "wq": _w((lambda *s: torch.randn(*s, dtype=torch.bfloat16) * 1.6)(D, Hq * Dh) * (D ** -0.5)),
            "wo": _w((lambda *s: torch.randn(*s, dtype=torch.bfloat16) * 0.2)(Hq * Dh, D) * ((Hq * Dh) ** -0.5)),
        }
    _B_in = _B_setup()

    return {
        "A_x": _A_in["x"],
        "A_k_cache": _A_in["k_cache"],
        "A_v_cache": _A_in["v_cache"],
        "A_wq": _A_in["wq"],
        "A_wo": _A_in["wo"],
        "B_x": _B_in["x"],
        "B_k_cache": _B_in["k_cache"],
        "B_v_cache": _B_in["v_cache"],
        "B_wq": _B_in["wq"],
        "B_wo": _B_in["wo"],
    }

def reference(A_x, A_k_cache, A_v_cache, A_wq, A_wo, B_x, B_k_cache, B_v_cache, B_wq, B_wo):
    def _A_ref(x, k_cache, v_cache, wq, wo):
        B, Sq, D = x.shape
        H, Dh = 32, 128
        q = (lambda x, *d: x.permute(*d))((x @ wq).reshape(B, Sq, H, Dh), 0, 2, 1, 3)
        scores = torch.einsum("bhqd,bhkd->bhqk", q, k_cache) * (Dh ** -0.5)
        p = _softmax(scores, axis=-1)
        o = torch.einsum("bhqk,bhkd->bhqd", p, v_cache)
        return (lambda x, *d: x.permute(*d))(o, 0, 2, 1, 3).reshape(B, Sq, H * Dh) @ wo

    def _B_ref(x, k_cache, v_cache, wq, wo):
        B, Sq, D = x.shape
        Hq, Dh = 32, 128
        Hkv, Sk = k_cache.shape[1], k_cache.shape[2]
        W = min(4096, max(256, Sk // 4))
        rep = Hq // Hkv
        q = (lambda x, *d: x.permute(*d))((x @ wq).reshape(B, Sq, Hq, Dh), 0, 2, 1, 3)
        k = (lambda x, n, axis: torch.repeat_interleave(x, n, dim=axis))(k_cache[:, :, Sk - W:, :], rep, axis=1)
        v = (lambda x, n, axis: torch.repeat_interleave(x, n, dim=axis))(v_cache[:, :, Sk - W:, :], rep, axis=1)
        scores = torch.einsum("bhqd,bhkd->bhqk", q, k) * (Dh ** -0.5)
        p = _softmax(scores, axis=-1)
        o = torch.einsum("bhqk,bhkd->bhqd", p, v)
        return (lambda x, *d: x.permute(*d))(o, 0, 2, 1, 3).reshape(B, Sq, Hq * Dh) @ wo

    a = _A_ref(A_x, A_k_cache, A_v_cache, A_wq, A_wo)
    b = _B_ref(B_x, B_k_cache, B_v_cache, B_wq, B_wo)
    return torch.concatenate([a, b], axis=-1)
```

```asm
; @launch grid=(256,1,1) block=(512,1,1) lds=18464
.amdgcn_target "amdgcn-amd-amdhsa--gfx950"
.text
.globl concat_heads__mha_block_cached__sliding_block_cached__decode_kernel
.p2align 8
.type concat_heads__mha_block_cached__sliding_block_cached__decode_kernel,@function
concat_heads__mha_block_cached__sliding_block_cached__decode_kernel:
    s_load_dwordx4 s[4:7], s[0:1], 0
    s_load_dwordx2 s[28:29], s[0:1], 24
    s_load_dwordx2 s[16:17], s[0:1], 0
    s_load_dwordx2 s[14:15], s[0:1], 96
    s_cmp_ge_u32 s2, 256
    s_cbranch_scc1 L_exit
    s_lshr_b32 s40, s2, 3
    s_and_b32 s41, s2, 7
    s_cmp_lt_u32 s40, 4
    s_cbranch_scc1 L_pathB
    s_load_dwordx2 s[8:9], s[0:1], 16
    s_load_dwordx2 s[12:13], s[0:1], 32
    s_setprio 3
    s_sub_u32 s40, s40, 4
    v_and_b32 v4, 0x1e0, v0
    s_mul_i32 s46, s40, 37
    v_bfe_i32 v251, v0, 4, 1
    s_lshr_b32 s46, s46, 8
    v_lshlrev_b32 v4, 13, v4
    s_xor_b32 s41, s41, 1
    v_and_b32 v255, 0xa4000, v251
    s_lshl3_add_u32 s42, s46, s41
    v_xor_b32 v4, v4, v255
    s_lshl_b32 s53, s42, 8
    v_and_b32 v13, 15, v0
    s_mov_b32 s30, 0x400000
    v_lshl_or_b32 v4, v13, 4, v4
    s_mov_b32 s31, 0x00020000
    s_mul_i32 s43, s46, 7
    s_sub_u32 s43, s40, s43
    s_lshl_b32 s62, s43, 14
    v_xor_b32 v4, s62, v4
    v_lshrrev_b32 v12, 6, v0
    s_nop 0
    v_readfirstlane_b32 s3, v12
    s_nop 0
    s_lshl3_add_u32 s46, s43, s3
    s_mul_i32 s49, s46, 37
    s_lshr_b32 s49, s49, 9
    s_lshl_b32 s50, s49, 5
    s_add_u32 s50, s50, s42
    s_and_b32 s48, s46, 15
    s_waitcnt lgkmcnt(0)
    buffer_load_dwordx4 v[100:103], v4, s[28:31], s53 offen
    v_xor_b32 v255, 0x2000, v4
    buffer_load_dwordx4 v[104:107], v255, s[28:31], s53 offen
    v_xor_b32 v254, 0x4000, v4
    buffer_load_dwordx4 v[108:111], v254, s[28:31], s53 offen
    v_xor_b32 v255, 0x6000, v4
    buffer_load_dwordx4 v[112:115], v255, s[28:31], s53 offen
    s_setprio 0
    s_barrier
    s_lshl4_add_u32 s48, s50, s48
    s_bitcmp1_b32 s48, 0
    v_and_b32 v2, 0x30, v0
    s_cselect_b32 s56, 0xc4000, 0
    v_and_b32 v15, 3, v0
    s_bitcmp1_b32 s48, 1
    v_lshlrev_b32 v2, 2, v2
    s_cselect_b32 s51, 0x64500, 0
    v_lshl_or_b32 v2, v15, 4, v2
    s_xor_b32 s56, s56, s51
    v_bfe_i32 v14, v0, 2, 1
    s_bitcmp1_b32 s48, 2
    v_and_b32 v14, 0x11300, v14
    s_cselect_b32 s51, 0x25100, 0
    v_xor_b32 v2, v2, v14
    s_xor_b32 s56, s56, s51
    v_bfe_i32 v14, v0, 3, 1
    s_bitcmp1_b32 s48, 3
    v_and_b32 v14, 0x3300, v14
    s_cselect_b32 s51, 0x9d800, 0
    v_xor_b32 v2, v2, v14
    s_xor_b32 s56, s56, s51
    s_bitcmp1_b32 s48, 4
    s_cselect_b32 s51, 0xba300, 0
    s_xor_b32 s56, s56, s51
    s_bitcmp1_b32 s48, 5
    s_cselect_b32 s51, 0x9e700, 0
    s_xor_b32 s56, s56, s51
    s_bitcmp1_b32 s48, 6
    s_cselect_b32 s51, 0xffb00, 0
    s_xor_b32 s56, s56, s51
    s_bitcmp1_b32 s48, 7
    s_cselect_b32 s51, 0xb4700, 0
    s_xor_b32 s56, s56, s51
    s_bitcmp1_b32 s48, 8
    s_cselect_b32 s51, 0x21b00, 0
    s_xor_b32 s56, s56, s51
    s_bitcmp1_b32 s48, 9
    s_cselect_b32 s51, 0xaf200, 0
    s_xor_b32 s56, s56, s51
    s_bitcmp1_b32 s48, 10
    s_cselect_b32 s51, 0x87900, 0
    s_xor_b32 s56, s56, s51
    s_lshl_b32 s47, s50, 20
    s_mov_b32 s22, 0x100000
    s_mov_b32 s23, 0x00020000
    s_add_u32 s20, s6, s47
    s_addc_u32 s21, s7, 0
    v_xor_b32 v252, s56, v2
    buffer_load_dwordx4 v[164:167], v252, s[20:23], 0 offen nt
    s_xor_b32 s55, s56, 0x18300
    v_xor_b32 v253, s55, v2
    buffer_load_dwordx4 v[168:171], v253, s[20:23], 0 offen nt
    s_xor_b32 s55, s56, 0x6f700
    v_xor_b32 v252, s55, v2
    buffer_load_dwordx4 v[172:175], v252, s[20:23], 0 offen nt
    s_xor_b32 s55, s56, 0x77400
    v_xor_b32 v253, s55, v2
    buffer_load_dwordx4 v[176:179], v253, s[20:23], 0 offen nt
    s_xor_b32 s55, s56, 0xa0300
    v_xor_b32 v252, s55, v2
    v_and_b32 v16, 0x1f0, v0
    s_mov_b32 s18, 0x1000
    v_bfe_u32 v17, v0, 2, 2
    s_mov_b32 s19, 0x00020000
    v_lshlrev_b32 v16, 1, v16
    v_and_b32 v251, 0x80, v251
    v_lshl_or_b32 v16, v17, 10, v16
    v_xor_b32 v16, v16, v251
    buffer_load_dwordx4 v[72:75], v16, s[16:19], 0 offen
    buffer_load_dwordx4 v[76:79], v16, s[16:19], 0 offen offset:16
    buffer_load_dwordx4 v[180:183], v252, s[20:23], 0 offen nt
    s_xor_b32 s55, s56, 0xb8000
    v_xor_b32 v253, s55, v2
    buffer_load_dwordx4 v[184:187], v253, s[20:23], 0 offen nt
    s_xor_b32 s55, s56, 0xcf400
    v_xor_b32 v252, s55, v2
    buffer_load_dwordx4 v[188:191], v252, s[20:23], 0 offen nt
    s_xor_b32 s55, s56, 0xd7700
    v_xor_b32 v253, s55, v2
    buffer_load_dwordx4 v[192:195], v253, s[20:23], 0 offen nt
    s_xor_b32 s55, s56, 0xaaa00
    v_xor_b32 v252, s55, v2
    buffer_load_dwordx4 v[196:199], v252, s[20:23], 0 offen nt
    s_xor_b32 s55, s56, 0xb2900
    v_xor_b32 v253, s55, v2
    buffer_load_dwordx4 v[200:203], v253, s[20:23], 0 offen nt
    s_xor_b32 s55, s56, 0xc5d00
    v_xor_b32 v252, s55, v2
    v_and_b32 v1, 63, v0
    s_mov_b32 s51, 0x100000
    s_lshl_b32 s52, s3, 7
    s_add_u32 s24, s8, s47
    s_addc_u32 s25, s9, 0
    s_and_b32 s25, s25, 0xffff
    s_mov_b32 s26, s51
    s_mov_b32 s27, 0x00020000
    s_mov_b32 s32, s12
    s_and_b32 s33, s13, 0xffff
    s_mov_b32 s34, 0x400000
    s_mov_b32 s35, 0x00020000
    s_mov_b32 s36, s14
    s_and_b32 s37, s15, 0xffff
    s_mov_b32 s38, 0x200000
    s_mov_b32 s39, 0x00020000
    v_and_b32 v3, 15, v1
    v_lshlrev_b32 v3, 4, v3
    v_bfe_i32 v17, v1, 4, 1
    v_and_b32 v17, 0x11300, v17
    v_xor_b32 v3, v3, v17
    v_bfe_i32 v17, v1, 5, 1
    v_and_b32 v17, 0x3300, v17
    v_xor_b32 v3, v3, v17
    v_lshrrev_b32 v5, 3, v1
    v_lshlrev_b32 v5, 10, v5
    v_and_b32 v17, 7, v1
    v_lshl_add_u32 v5, v17, 4, v5
    s_lshl_b32 s57, s42, 17
    s_add_u32 s57, s57, s52
    s_lshr_b32 s58, s43, 1
    s_lshl_b32 s66, s58, 2
    s_add_u32 s66, s66, 1581056
    s_load_dword s67, s[14:15], s66
    s_add_u32 s66, s66, 4
    s_load_dword s68, s[14:15], s66
    s_load_dwordx2 s[90:91], s[0:1], 80
    s_sub_u32 s59, s49, s58
    s_xor_b32 s65, s56, 0xdcc00
    s_bitcmp1_b32 s48, 1
    s_cselect_b32 s63, 0x7c600, 0
    s_xor_b32 s65, s65, s63
    s_bitcmp1_b32 s48, 2
    s_cselect_b32 s63, 0x4a600, 0
    s_xor_b32 s65, s65, s63
    s_bitcmp1_b32 s48, 3
    s_cselect_b32 s63, 0x37200, 0
    s_xor_b32 s65, s65, s63
    s_bitcmp1_b32 s48, 9
    s_cselect_b32 s63, 0x64500, 0
    s_xor_b32 s65, s65, s63
    s_bitcmp1_b32 s48, 10
    s_cselect_b32 s63, 0x25100, 0
    s_xor_b32 s65, s65, s63
    s_xor_b32 s60, s56, 0x2b500
    s_bitcmp1_b32 s48, 1
    s_cselect_b32 s63, 0x64500, 0
    s_xor_b32 s60, s60, s63
    s_bitcmp1_b32 s48, 2
    s_cselect_b32 s63, 0x25100, 0
    s_xor_b32 s60, s60, s63
    s_bitcmp1_b32 s48, 3
    s_cselect_b32 s63, 0x9d800, 0
    s_xor_b32 s60, s60, s63
    s_bitcmp1_b32 s48, 9
    s_cselect_b32 s63, 0x60c00, 0
    s_xor_b32 s60, s60, s63
    s_bitcmp1_b32 s48, 10
    s_cselect_b32 s63, 0xea500, 0
    s_xor_b32 s60, s60, s63
    s_and_b32 s62, s48, 15
    s_bitcmp1_b32 0x90, s62
    s_cselect_b32 s60, s60, 0x100000
    s_cselect_b32 s54, 2, 1
    s_xor_b32 s62, s56, 0x1200
    s_bitcmp1_b32 s48, 1
    s_cselect_b32 s63, 0x78f00, 0
    s_xor_b32 s62, s62, s63
    s_bitcmp1_b32 s48, 2
    s_cselect_b32 s63, 0x85200, 0
    s_xor_b32 s62, s62, s63
    s_bitcmp1_b32 s48, 3
    s_cselect_b32 s63, 0xb600, 0
    s_xor_b32 s62, s62, s63
    s_bitcmp1_b32 s48, 9
    s_cselect_b32 s63, 0x7c600, 0
    s_xor_b32 s62, s62, s63
    s_bitcmp1_b32 s48, 10
    s_cselect_b32 s63, 0x4a600, 0
    s_xor_b32 s62, s62, s63
    s_mov_b32 s48, s62
    s_mov_b32 s61, 0x3e0293ee
    v_lshlrev_b32 v12, 2, v0
    v_mov_b32 v13, 0
    ds_write_b32 v12, v13 offset:16384
    v_and_b32 v12, 12, v12
    v_mov_b32 v14, 0xff800000
    ds_write_b32 v12, v14 offset:18432
    ds_write_b32 v12, v13 offset:18448
    v_and_b32 v12, 3, v1
    v_lshlrev_b32 v12, 4, v12
    v_mov_b32 v14, 0xffff
    v_mov_b32 v15, 0
    v_lshlrev_b64 v[6:7], v12, v[14:15]
    v_mov_b32 v13, 0x0c0c0c0c
    s_mov_b32 s44, 0x01000100
    s_mov_b32 s45, 0x03020302
    v_bfi_b32 v8, v6, s44, v13
    v_bfi_b32 v9, v7, s44, v13
    v_bfi_b32 v10, v6, s45, v13
    v_bfi_b32 v11, v7, s45, v13
    v_mov_b32 v20, 0
    v_mov_b32 v21, 0
    v_mov_b32 v24, 0
    v_mov_b32 v25, 0
    v_mov_b32 v28, 0
    v_mov_b32 v29, 0
    v_mov_b32 v32, 0
    v_mov_b32 v33, 0
    v_mov_b32 v36, 0
    v_mov_b32 v37, 0
    s_waitcnt vmcnt(15)
    s_waitcnt vmcnt(6)
    s_bitcmp1_b32 s43, 0
    s_cselect_b32 s62, -1, 0
    s_xor_b32 exec_lo, s62, 0xffff0000
    s_mov_b32 exec_hi, exec_lo
    v_swap_b32 v72, v73
    v_swap_b32 v74, v75
    v_swap_b32 v76, v77
    v_swap_b32 v78, v79
    s_mov_b64 exec, -1
    s_bitcmp0_b32 s43, 1
    s_cbranch_scc1 L_rq1
    v_swap_b32 v72, v74
    v_swap_b32 v73, v75
    v_swap_b32 v76, v78
    v_swap_b32 v77, v79
L_rq1:
    s_bitcmp0_b32 s43, 2
    s_cbranch_scc1 L_rq2
    v_swap_b32 v72, v76
    v_swap_b32 v73, v77
    v_swap_b32 v74, v78
    v_swap_b32 v75, v79
L_rq2:
    v_perm_b32 v22, v72, v72, v8
    v_perm_b32 v23, v72, v72, v9
    s_nop 1
    v_mfma_f32_16x16x32_bf16 v[56:59], v[22:25], v[100:103], 0
    v_mfma_f32_16x16x32_bf16 v[60:63], v[20:23], v[100:103], 0
    v_xor_b32 v254, 0x8000, v4
    buffer_load_dwordx4 v[116:119], v254, s[28:31], s53 offen
    buffer_load_dwordx4 v[204:207], v252, s[20:23], 0 offen nt
    s_xor_b32 s55, s56, 0xdde00
    v_xor_b32 v253, s55, v2
    buffer_load_dwordx4 v[208:211], v253, s[20:23], 0 offen nt
    s_xor_b32 s55, s56, 0xa900
    v_xor_b32 v252, s55, v2
    v_perm_b32 v26, v72, v72, v10
    v_perm_b32 v27, v72, v72, v11
    s_nop 1
    v_mfma_f32_16x16x32_bf16 v[56:59], v[26:29], v[104:107], v[56:59]
    v_mfma_f32_16x16x32_bf16 v[60:63], v[24:27], v[104:107], v[60:63]
    v_xor_b32 v255, 0xa000, v4
    buffer_load_dwordx4 v[120:123], v255, s[28:31], s53 offen
    buffer_load_dwordx4 v[212:215], v252, s[20:23], 0 offen nt
    s_xor_b32 s55, s56, 0x12a00
    v_xor_b32 v253, s55, v2
    buffer_load_dwordx4 v[216:219], v253, s[20:23], 0 offen nt
    s_xor_b32 s55, s65, 0x0
    v_xor_b32 v252, s55, v2
    v_perm_b32 v30, v73, v73, v8
    v_perm_b32 v31, v73, v73, v9
    s_nop 1
    v_mfma_f32_16x16x32_bf16 v[56:59], v[30:33], v[108:111], v[56:59]
    v_mfma_f32_16x16x32_bf16 v[60:63], v[28:31], v[108:111], v[60:63]
    v_xor_b32 v254, 0xc000, v4
    buffer_load_dwordx4 v[124:127], v254, s[28:31], s53 offen
    buffer_load_dwordx4 v[220:223], v252, s[20:23], 0 offen nt
    s_xor_b32 s55, s56, 0x65e00
    v_xor_b32 v253, s55, v2
    buffer_load_dwordx4 v[224:227], v253, s[20:23], 0 offen nt
    s_xor_b32 s55, s56, 0x7dd00
    v_xor_b32 v252, s55, v2
    v_perm_b32 v34, v73, v73, v10
    v_perm_b32 v35, v73, v73, v11
    s_nop 1
    v_mfma_f32_16x16x32_bf16 v[56:59], v[34:37], v[112:115], v[56:59]
    v_mfma_f32_16x16x32_bf16 v[60:63], v[32:35], v[112:115], v[60:63]
    v_xor_b32 v255, 0xe000, v4
    buffer_load_dwordx4 v[128:131], v255, s[28:31], s53 offen
    buffer_load_dwordx4 v[228:231], v252, s[20:23], 0 offen nt
    s_xor_b32 s55, s56, 0x1ca00
    v_xor_b32 v253, s55, v2
    buffer_load_dwordx4 v[232:235], v253, s[20:23], 0 offen nt
    s_xor_b32 s55, s56, 0x4900
    v_xor_b32 v252, s55, v2
    s_waitcnt vmcnt(11)
    v_perm_b32 v22, v74, v74, v8
    v_perm_b32 v23, v74, v74, v9
    s_nop 1
    v_mfma_f32_16x16x32_bf16 v[56:59], v[22:25], v[116:119], v[56:59]
    v_mfma_f32_16x16x32_bf16 v[60:63], v[20:23], v[116:119], v[60:63]
    v_xor_b32 v254, 0x10000, v4
    buffer_load_dwordx4 v[132:135], v254, s[28:31], s53 offen
    buffer_load_dwordx4 v[236:239], v252, s[20:23], 0 offen nt
    s_xor_b32 s55, s56, 0x73d00
    v_xor_b32 v253, s55, v2
    buffer_load_dwordx4 v[240:243], v253, s[20:23], 0 offen nt
    s_xor_b32 s55, s56, 0x6be00
    v_xor_b32 v252, s55, v2
    s_waitcnt vmcnt(11)
    v_perm_b32 v26, v74, v74, v10
    v_perm_b32 v27, v74, v74, v11
    s_nop 1
    v_mfma_f32_16x16x32_bf16 v[56:59], v[26:29], v[120:123], v[56:59]
    v_mfma_f32_16x16x32_bf16 v[60:63], v[24:27], v[120:123], v[60:63]
    v_xor_b32 v255, 0x12000, v4
    buffer_load_dwordx4 v[136:139], v255, s[28:31], s53 offen
    buffer_load_dwordx4 v[244:247], v252, s[20:23], 0 offen nt
    s_xor_b32 s55, s65, 0x1ca00
    v_xor_b32 v253, s55, v2
    buffer_load_dwordx4 v[248:251], v253, s[20:23], 0 offen nt
    s_xor_b32 s55, s56, 0xbc900
    v_xor_b32 v252, s55, v2
    s_waitcnt vmcnt(11)
    v_perm_b32 v30, v75, v75, v8
    v_perm_b32 v31, v75, v75, v9
    s_nop 1
    v_mfma_f32_16x16x32_bf16 v[56:59], v[30:33], v[124:127], v[56:59]
    v_mfma_f32_16x16x32_bf16 v[60:63], v[28:31], v[124:127], v[60:63]
    v_xor_b32 v254, 0x14000, v4
    buffer_load_dwordx4 v[140:143], v254, s[28:31], s53 offen
    buffer_load_dwordx4 v[100:103], v252, s[20:23], 0 offen nt
    s_xor_b32 s55, s56, 0xa4a00
    v_xor_b32 v253, s55, v2
    buffer_load_dwordx4 v[104:107], v253, s[20:23], 0 offen nt
    s_xor_b32 s55, s56, 0xd3e00
    v_xor_b32 v252, s55, v2
    s_waitcnt vmcnt(11)
    v_perm_b32 v34, v75, v75, v10
    v_perm_b32 v35, v75, v75, v11
    s_nop 1
    v_mfma_f32_16x16x32_bf16 v[56:59], v[34:37], v[128:131], v[56:59]
    v_mfma_f32_16x16x32_bf16 v[60:63], v[32:35], v[128:131], v[60:63]
    v_xor_b32 v255, 0x16000, v4
    buffer_load_dwordx4 v[144:147], v255, s[28:31], s53 offen
    buffer_load_dwordx4 v[108:111], v252, s[20:23], 0 offen nt
    s_xor_b32 s55, s56, 0xcbd00
    v_xor_b32 v253, s55, v2
    buffer_load_dwordx4 v[112:115], v253, s[20:23], 0 offen nt
    s_xor_b32 s55, s65, 0xa0300
    v_xor_b32 v252, s55, v2
    s_waitcnt vmcnt(11)
    v_perm_b32 v22, v76, v76, v8
    v_perm_b32 v23, v76, v76, v9
    s_nop 1
    v_mfma_f32_16x16x32_bf16 v[56:59], v[22:25], v[132:135], v[56:59]
    v_mfma_f32_16x16x32_bf16 v[60:63], v[20:23], v[132:135], v[60:63]
    v_xor_b32 v254, 0x18000, v4
    buffer_load_dwordx4 v[148:151], v254, s[28:31], s53 offen
    buffer_load_dwordx4 v[116:119], v252, s[20:23], 0 offen nt
    s_xor_b32 s55, s56, 0xb6000
    v_xor_b32 v253, s55, v2
    buffer_load_dwordx4 v[120:123], v253, s[20:23], 0 offen nt
    s_xor_b32 s55, s56, 0xae300
    v_xor_b32 v252, s55, v2
    s_waitcnt vmcnt(11)
    v_perm_b32 v26, v76, v76, v10
    v_perm_b32 v27, v76, v76, v11
    s_nop 1
    v_mfma_f32_16x16x32_bf16 v[56:59], v[26:29], v[136:139], v[56:59]
    v_mfma_f32_16x16x32_bf16 v[60:63], v[24:27], v[136:139], v[60:63]
    v_xor_b32 v255, 0x1a000, v4
    buffer_load_dwordx4 v[152:155], v255, s[28:31], s53 offen
    buffer_load_dwordx4 v[124:127], v252, s[20:23], 0 offen nt
    s_xor_b32 s55, s65, 0xbc900
    v_xor_b32 v253, s55, v2
    buffer_load_dwordx4 v[128:131], v253, s[20:23], 0 offen nt
    s_xor_b32 s55, s56, 0xd9700
    v_xor_b32 v252, s55, v2
    s_waitcnt vmcnt(11)
    v_perm_b32 v30, v77, v77, v8
    v_perm_b32 v31, v77, v77, v9
    s_nop 1
    v_mfma_f32_16x16x32_bf16 v[56:59], v[30:33], v[140:143], v[56:59]
    v_mfma_f32_16x16x32_bf16 v[60:63], v[28:31], v[140:143], v[60:63]
    v_xor_b32 v254, 0x1c000, v4
    buffer_load_dwordx4 v[156:159], v254, s[28:31], s53 offen
    buffer_load_dwordx4 v[132:135], v252, s[20:23], 0 offen nt
    s_xor_b32 s55, s56, 0xc1400
    v_xor_b32 v253, s55, v2
    buffer_load_dwordx4 v[136:139], v253, s[20:23], 0 offen nt
    s_xor_b32 s55, s56, 0x16300
    v_xor_b32 v252, s55, v2
    s_waitcnt vmcnt(11)
    v_perm_b32 v34, v77, v77, v10
    v_perm_b32 v35, v77, v77, v11
    s_nop 1
    v_mfma_f32_16x16x32_bf16 v[56:59], v[34:37], v[144:147], v[56:59]
    v_mfma_f32_16x16x32_bf16 v[60:63], v[32:35], v[144:147], v[60:63]
    v_xor_b32 v255, 0x1e000, v4
    buffer_load_dwordx4 v[160:163], v255, s[28:31], s53 offen
    buffer_load_dwordx4 v[140:143], v252, s[20:23], 0 offen nt
    s_xor_b32 s55, s56, 0xe000
    v_xor_b32 v253, s55, v2
    buffer_load_dwordx4 v[144:147], v253, s[20:23], 0 offen nt
    s_xor_b32 s55, s56, 0x79400
    v_xor_b32 v252, s55, v2
    s_waitcnt vmcnt(11)
    v_perm_b32 v22, v78, v78, v8
    v_perm_b32 v23, v78, v78, v9
    s_nop 1
    v_mfma_f32_16x16x32_bf16 v[56:59], v[22:25], v[148:151], v[56:59]
    v_mfma_f32_16x16x32_bf16 v[60:63], v[20:23], v[148:151], v[60:63]
    buffer_load_dwordx4 v[148:151], v252, s[20:23], 0 offen nt
    s_xor_b32 s55, s56, 0x61700
    v_xor_b32 v253, s55, v2
    s_waitcnt vmcnt(9)
    v_perm_b32 v26, v78, v78, v10
    v_perm_b32 v27, v78, v78, v11
    s_nop 1
    v_mfma_f32_16x16x32_bf16 v[56:59], v[26:29], v[152:155], v[56:59]
    v_mfma_f32_16x16x32_bf16 v[60:63], v[24:27], v[152:155], v[60:63]
    buffer_load_dwordx4 v[152:155], v253, s[20:23], 0 offen nt
    s_xor_b32 s55, s65, 0x96e00
    v_xor_b32 v252, s55, v2
    s_waitcnt vmcnt(7)
    v_perm_b32 v30, v79, v79, v8
    v_perm_b32 v31, v79, v79, v9
    s_nop 1
    v_mfma_f32_16x16x32_bf16 v[56:59], v[30:33], v[156:159], v[56:59]
    v_mfma_f32_16x16x32_bf16 v[60:63], v[28:31], v[156:159], v[60:63]
    buffer_load_dwordx4 v[156:159], v252, s[20:23], 0 offen nt
    s_xor_b32 s55, s65, 0x8a400
    v_xor_b32 v253, s55, v2
    s_waitcnt vmcnt(5)
    v_perm_b32 v34, v79, v79, v10
    v_perm_b32 v35, v79, v79, v11
    s_nop 1
    v_mfma_f32_16x16x32_bf16 v[56:59], v[34:37], v[160:163], v[56:59]
    v_mfma_f32_16x16x32_bf16 v[60:63], v[32:35], v[160:163], v[60:63]
    buffer_load_dwordx4 v[160:163], v253, s[20:23], 0 offen nt
    s_xor_b32 s55, s65, 0x36d00
    v_xor_b32 v252, s55, v2
    v_lshlrev_b32 v12, 5, v0
    s_nop 2
    ds_write_b128 v12, v[56:59] offset:0
    ds_write_b128 v12, v[60:63] offset:16
    v_bfe_u32 v13, v1, 2, 2
    v_lshlrev_b32 v13, 12, v13
    v_lshrrev_b32 v14, 4, v1
    v_lshl_add_u32 v13, v14, 7, v13
    v_and_b32 v14, 3, v1
    v_lshl_add_u32 v13, v14, 5, v13
    s_lshl_b32 s62, s49, 9
    v_add_u32 v13, s62, v13
    v_mov_b32 v40, 0
    v_mov_b32 v41, 0
    v_mov_b32 v42, 0
    v_mov_b32 v43, 0
    v_mov_b32 v44, 0
    v_mov_b32 v45, 0
    v_mov_b32 v46, 0
    v_mov_b32 v47, 0
    v_mov_b32 v48, 0
    v_mov_b32 v49, 0
    v_mov_b32 v50, 0
    v_mov_b32 v51, 0
    v_mov_b32 v52, 0
    v_mov_b32 v53, 0
    v_mov_b32 v54, 0
    v_mov_b32 v55, 0
    v_mov_b32 v22, 0
    v_mov_b32 v23, 0
    v_mov_b32 v26, 0
    v_mov_b32 v27, 0
    v_mov_b32 v30, 0
    v_mov_b32 v31, 0
    v_mov_b32 v34, 0
    v_mov_b32 v35, 0
    s_waitcnt lgkmcnt(0)
    s_barrier
    ds_read_b128 v[80:83], v13 offset:0
    ds_read_b128 v[84:87], v13 offset:16
    ds_read_b128 v[88:91], v13 offset:2048
    ds_read_b128 v[92:95], v13 offset:2064
    s_waitcnt lgkmcnt(0)
    v_add_f32 v80, v80, v88
    v_add_f32 v81, v81, v89
    v_add_f32 v82, v82, v90
    v_add_f32 v83, v83, v91
    v_add_f32 v84, v84, v92
    v_add_f32 v85, v85, v93
    v_add_f32 v86, v86, v94
    v_add_f32 v87, v87, v95
    v_add_f32_dpp v88, v80, v80 row_ror:4 row_mask:0xf bank_mask:0xf
    v_add_f32_dpp v89, v81, v81 row_ror:4 row_mask:0xf bank_mask:0xf
    v_add_f32_dpp v90, v82, v82 row_ror:4 row_mask:0xf bank_mask:0xf
    v_add_f32_dpp v91, v83, v83 row_ror:4 row_mask:0xf bank_mask:0xf
    v_add_f32_dpp v92, v84, v84 row_ror:4 row_mask:0xf bank_mask:0xf
    v_add_f32_dpp v93, v85, v85 row_ror:4 row_mask:0xf bank_mask:0xf
    v_add_f32_dpp v94, v86, v86 row_ror:4 row_mask:0xf bank_mask:0xf
    v_add_f32_dpp v95, v87, v87 row_ror:4 row_mask:0xf bank_mask:0xf
    v_add_f32_dpp v80, v88, v88 row_ror:8 row_mask:0xf bank_mask:0xf
    v_add_f32_dpp v81, v89, v89 row_ror:8 row_mask:0xf bank_mask:0xf
    v_add_f32_dpp v82, v90, v90 row_ror:8 row_mask:0xf bank_mask:0xf
    v_add_f32_dpp v83, v91, v91 row_ror:8 row_mask:0xf bank_mask:0xf
    v_add_f32_dpp v84, v92, v92 row_ror:8 row_mask:0xf bank_mask:0xf
    v_add_f32_dpp v85, v93, v93 row_ror:8 row_mask:0xf bank_mask:0xf
    v_add_f32_dpp v86, v94, v94 row_ror:8 row_mask:0xf bank_mask:0xf
    v_add_f32_dpp v87, v95, v95 row_ror:8 row_mask:0xf bank_mask:0xf
    v_cvt_pk_bf16_f32 v88, v80, v81
    v_cvt_pk_bf16_f32 v89, v82, v83
    v_cvt_pk_bf16_f32 v90, v84, v85
    v_cvt_pk_bf16_f32 v91, v86, v87
    v_mov_b32_dpp v40, v88 quad_perm:[0,1,2,3] row_mask:0xf bank_mask:0x1
    v_mov_b32_dpp v41, v89 quad_perm:[0,1,2,3] row_mask:0xf bank_mask:0x1
    v_mov_b32_dpp v42, v90 quad_perm:[0,1,2,3] row_mask:0xf bank_mask:0x1
    v_mov_b32_dpp v43, v91 quad_perm:[0,1,2,3] row_mask:0xf bank_mask:0x1
    v_mov_b32_dpp v44, v88 quad_perm:[0,1,2,3] row_mask:0xf bank_mask:0x2
    v_mov_b32_dpp v45, v89 quad_perm:[0,1,2,3] row_mask:0xf bank_mask:0x2
    v_mov_b32_dpp v46, v90 quad_perm:[0,1,2,3] row_mask:0xf bank_mask:0x2
    v_mov_b32_dpp v47, v91 quad_perm:[0,1,2,3] row_mask:0xf bank_mask:0x2
    v_mov_b32_dpp v48, v88 quad_perm:[0,1,2,3] row_mask:0xf bank_mask:0x4
    v_mov_b32_dpp v49, v89 quad_perm:[0,1,2,3] row_mask:0xf bank_mask:0x4
    v_mov_b32_dpp v50, v90 quad_perm:[0,1,2,3] row_mask:0xf bank_mask:0x4
    v_mov_b32_dpp v51, v91 quad_perm:[0,1,2,3] row_mask:0xf bank_mask:0x4
    v_mov_b32_dpp v52, v88 quad_perm:[0,1,2,3] row_mask:0xf bank_mask:0x8
    v_mov_b32_dpp v53, v89 quad_perm:[0,1,2,3] row_mask:0xf bank_mask:0x8
    v_mov_b32_dpp v54, v90 quad_perm:[0,1,2,3] row_mask:0xf bank_mask:0x8
    v_mov_b32_dpp v55, v91 quad_perm:[0,1,2,3] row_mask:0xf bank_mask:0x8
    v_mfma_f32_16x16x32_bf16 v[64:67], v[164:167], v[40:43], 0
    buffer_load_dwordx4 v[164:167], v252, s[20:23], 0 offen nt
    s_xor_b32 s55, s56, 0x96e00
    v_xor_b32 v253, s55, v2
    v_mfma_f32_16x16x32_bf16 v[64:67], v[168:171], v[44:47], v[64:67]
    buffer_load_dwordx4 v[168:171], v253, s[20:23], 0 offen nt
    s_xor_b32 s55, s56, 0x8ed00
    v_xor_b32 v252, s55, v2
    v_mfma_f32_16x16x32_bf16 v[64:67], v[172:175], v[48:51], v[64:67]
    buffer_load_dwordx4 v[172:175], v252, s[20:23], 0 offen nt
    s_xor_b32 s55, s56, 0xf9900
    v_xor_b32 v253, s55, v2
    v_mfma_f32_16x16x32_bf16 v[64:67], v[176:179], v[52:55], v[64:67]
    buffer_load_dwordx4 v[176:179], v253, s[20:23], 0 offen nt
    s_xor_b32 s55, s56, 0xe1a00
    v_xor_b32 v252, s55, v2
    v_mfma_f32_16x16x32_bf16 v[68:71], v[180:183], v[40:43], 0
    buffer_load_dwordx4 v[180:183], v252, s[20:23], 0 offen nt
    s_xor_b32 s55, s56, 0x36d00
    v_xor_b32 v253, s55, v2
    v_mfma_f32_16x16x32_bf16 v[68:71], v[184:187], v[44:47], v[68:71]
    buffer_load_dwordx4 v[184:187], v253, s[20:23], 0 offen nt
    s_xor_b32 s55, s56, 0x2ee00
    v_xor_b32 v252, s55, v2
    v_mov_b32_dpp v80, v64 quad_perm:[0,0,0,0] row_mask:0xf bank_mask:0xf
    v_mov_b32_dpp v19, v66 quad_perm:[2,2,2,2] row_mask:0xf bank_mask:0xf
    s_nop 0
    v_add_f32_dpp v80, v65, v80 quad_perm:[1,1,1,1] row_mask:0xf bank_mask:0xf
    v_add_f32_dpp v19, v67, v19 quad_perm:[3,3,3,3] row_mask:0xf bank_mask:0xf
    v_add_f32 v80, v80, v19
    v_mfma_f32_16x16x32_bf16 v[68:71], v[188:191], v[48:51], v[68:71]
    buffer_load_dwordx4 v[188:191], v252, s[20:23], 0 offen nt
    s_xor_b32 s55, s56, 0x59a00
    v_xor_b32 v253, s55, v2
    v_mfma_f32_16x16x32_bf16 v[68:71], v[192:195], v[52:55], v[68:71]
    buffer_load_dwordx4 v[192:195], v253, s[20:23], 0 offen nt
    s_xor_b32 s55, s56, 0x41900
    v_xor_b32 v252, s55, v2
    v_mfma_f32_16x16x32_bf16 v[64:67], v[196:199], v[40:43], 0
    buffer_load_dwordx4 v[196:199], v252, s[20:23], 0 offen nt
    s_xor_b32 s55, s56, 0x3c400
    v_xor_b32 v253, s55, v2
    v_mfma_f32_16x16x32_bf16 v[64:67], v[200:203], v[44:47], v[64:67]
    buffer_load_dwordx4 v[200:203], v253, s[20:23], 0 offen nt
    s_xor_b32 s55, s56, 0x24700
    v_xor_b32 v252, s55, v2
    v_mov_b32_dpp v81, v68 quad_perm:[0,0,0,0] row_mask:0xf bank_mask:0xf
    v_mov_b32_dpp v19, v70 quad_perm:[2,2,2,2] row_mask:0xf bank_mask:0xf
    s_nop 0
    v_add_f32_dpp v81, v69, v81 quad_perm:[1,1,1,1] row_mask:0xf bank_mask:0xf
    v_add_f32_dpp v19, v71, v19 quad_perm:[3,3,3,3] row_mask:0xf bank_mask:0xf
    v_add_f32 v81, v81, v19
    v_mfma_f32_16x16x32_bf16 v[64:67], v[204:207], v[48:51], v[64:67]
    buffer_load_dwordx4 v[204:207], v252, s[20:23], 0 offen nt
    s_xor_b32 s55, s65, 0x2a700
    v_xor_b32 v253, s55, v2
    v_mfma_f32_16x16x32_bf16 v[64:67], v[208:211], v[52:55], v[64:67]
    buffer_load_dwordx4 v[208:211], v253, s[20:23], 0 offen nt
    s_xor_b32 s55, s56, 0x53300
    v_xor_b32 v252, s55, v2
    v_mfma_f32_16x16x32_bf16 v[68:71], v[212:215], v[40:43], 0
    buffer_load_dwordx4 v[212:215], v252, s[20:23], 0 offen nt
    s_xor_b32 s55, s56, 0x4b000
    v_xor_b32 v253, s55, v2
    v_mfma_f32_16x16x32_bf16 v[68:71], v[216:219], v[44:47], v[68:71]
    buffer_load_dwordx4 v[216:219], v253, s[20:23], 0 offen nt
    s_xor_b32 s55, s56, 0x9c700
    v_xor_b32 v252, s55, v2
    v_mov_b32_dpp v82, v64 quad_perm:[0,0,0,0] row_mask:0xf bank_mask:0xf
    v_mov_b32_dpp v19, v66 quad_perm:[2,2,2,2] row_mask:0xf bank_mask:0xf
    s_nop 0
    v_add_f32_dpp v82, v65, v82 quad_perm:[1,1,1,1] row_mask:0xf bank_mask:0xf
    v_add_f32_dpp v19, v67, v19 quad_perm:[3,3,3,3] row_mask:0xf bank_mask:0xf
    v_add_f32 v82, v82, v19
    v_mfma_f32_16x16x32_bf16 v[68:71], v[220:223], v[48:51], v[68:71]
    buffer_load_dwordx4 v[220:223], v252, s[20:23], 0 offen nt
    s_xor_b32 s55, s56, 0x84400
    v_xor_b32 v253, s55, v2
    v_mfma_f32_16x16x32_bf16 v[68:71], v[224:227], v[52:55], v[68:71]
    buffer_load_dwordx4 v[224:227], v253, s[20:23], 0 offen nt
    s_xor_b32 s55, s56, 0xf3000
    v_xor_b32 v252, s55, v2
    v_mfma_f32_16x16x32_bf16 v[64:67], v[228:231], v[40:43], 0
    buffer_load_dwordx4 v[228:231], v252, s[20:23], 0 offen nt
    s_xor_b32 s55, s56, 0xeb300
    v_xor_b32 v253, s55, v2
    v_mfma_f32_16x16x32_bf16 v[64:67], v[232:235], v[44:47], v[64:67]
    buffer_load_dwordx4 v[232:235], v253, s[20:23], 0 offen nt
    s_xor_b32 s55, s56, 0x8a400
    v_xor_b32 v252, s55, v2
    v_mov_b32_dpp v83, v68 quad_perm:[0,0,0,0] row_mask:0xf bank_mask:0xf
    v_mov_b32_dpp v19, v70 quad_perm:[2,2,2,2] row_mask:0xf bank_mask:0xf
    s_nop 0
    v_add_f32_dpp v83, v69, v83 quad_perm:[1,1,1,1] row_mask:0xf bank_mask:0xf
    v_add_f32_dpp v19, v71, v19 quad_perm:[3,3,3,3] row_mask:0xf bank_mask:0xf
    v_add_f32 v83, v83, v19
    v_mfma_f32_16x16x32_bf16 v[64:67], v[236:239], v[48:51], v[64:67]
    v_mfma_f32_16x16x32_bf16 v[64:67], v[240:243], v[52:55], v[64:67]
    v_mfma_f32_16x16x32_bf16 v[68:71], v[244:247], v[40:43], 0
    v_mfma_f32_16x16x32_bf16 v[68:71], v[248:251], v[44:47], v[68:71]
    s_nop 5
    v_mov_b32_dpp v84, v64 quad_perm:[0,0,0,0] row_mask:0xf bank_mask:0xf
    v_mov_b32_dpp v19, v66 quad_perm:[2,2,2,2] row_mask:0xf bank_mask:0xf
    s_nop 0
    v_add_f32_dpp v84, v65, v84 quad_perm:[1,1,1,1] row_mask:0xf bank_mask:0xf
    v_add_f32_dpp v19, v67, v19 quad_perm:[3,3,3,3] row_mask:0xf bank_mask:0xf
    v_add_f32 v84, v84, v19
    v_mfma_f32_16x16x32_bf16 v[68:71], v[100:103], v[48:51], v[68:71]
    v_mfma_f32_16x16x32_bf16 v[68:71], v[104:107], v[52:55], v[68:71]
    v_mfma_f32_16x16x32_bf16 v[64:67], v[108:111], v[40:43], 0
    v_mfma_f32_16x16x32_bf16 v[64:67], v[112:115], v[44:47], v[64:67]
    s_nop 5
    v_mov_b32_dpp v85, v68 quad_perm:[0,0,0,0] row_mask:0xf bank_mask:0xf
    v_mov_b32_dpp v19, v70 quad_perm:[2,2,2,2] row_mask:0xf bank_mask:0xf
    s_nop 0
    v_add_f32_dpp v85, v69, v85 quad_perm:[1,1,1,1] row_mask:0xf bank_mask:0xf
    v_add_f32_dpp v19, v71, v19 quad_perm:[3,3,3,3] row_mask:0xf bank_mask:0xf
    v_add_f32 v85, v85, v19
    v_mfma_f32_16x16x32_bf16 v[64:67], v[116:119], v[48:51], v[64:67]
    v_mfma_f32_16x16x32_bf16 v[64:67], v[120:123], v[52:55], v[64:67]
    v_mfma_f32_16x16x32_bf16 v[68:71], v[124:127], v[40:43], 0
    v_mfma_f32_16x16x32_bf16 v[68:71], v[128:131], v[44:47], v[68:71]
    s_nop 5
    v_mov_b32_dpp v86, v64 quad_perm:[0,0,0,0] row_mask:0xf bank_mask:0xf
    v_mov_b32_dpp v19, v66 quad_perm:[2,2,2,2] row_mask:0xf bank_mask:0xf
    s_nop 0
    v_add_f32_dpp v86, v65, v86 quad_perm:[1,1,1,1] row_mask:0xf bank_mask:0xf
    v_add_f32_dpp v19, v67, v19 quad_perm:[3,3,3,3] row_mask:0xf bank_mask:0xf
    v_add_f32 v86, v86, v19
    v_mfma_f32_16x16x32_bf16 v[68:71], v[132:135], v[48:51], v[68:71]
    v_mfma_f32_16x16x32_bf16 v[68:71], v[136:139], v[52:55], v[68:71]
    s_waitcnt vmcnt(23)
    v_mfma_f32_16x16x32_bf16 v[64:67], v[140:143], v[40:43], 0
    s_waitcnt vmcnt(22)
    v_mfma_f32_16x16x32_bf16 v[64:67], v[144:147], v[44:47], v[64:67]
    s_nop 3
    v_mov_b32_dpp v87, v68 quad_perm:[0,0,0,0] row_mask:0xf bank_mask:0xf
    v_mov_b32_dpp v19, v70 quad_perm:[2,2,2,2] row_mask:0xf bank_mask:0xf
    s_nop 0
    v_add_f32_dpp v87, v69, v87 quad_perm:[1,1,1,1] row_mask:0xf bank_mask:0xf
    v_add_f32_dpp v19, v71, v19 quad_perm:[3,3,3,3] row_mask:0xf bank_mask:0xf
    v_add_f32 v87, v87, v19
    s_waitcnt vmcnt(21)
    v_mfma_f32_16x16x32_bf16 v[64:67], v[148:151], v[48:51], v[64:67]
    s_waitcnt vmcnt(20)
    v_mfma_f32_16x16x32_bf16 v[64:67], v[152:155], v[52:55], v[64:67]
    s_waitcnt vmcnt(19)
    v_mfma_f32_16x16x32_bf16 v[68:71], v[156:159], v[40:43], 0
    s_waitcnt vmcnt(18)
    v_mfma_f32_16x16x32_bf16 v[68:71], v[160:163], v[44:47], v[68:71]
    s_nop 3
    v_mov_b32_dpp v88, v64 quad_perm:[0,0,0,0] row_mask:0xf bank_mask:0xf
    v_mov_b32_dpp v19, v66 quad_perm:[2,2,2,2] row_mask:0xf bank_mask:0xf
    s_nop 0
    v_add_f32_dpp v88, v65, v88 quad_perm:[1,1,1,1] row_mask:0xf bank_mask:0xf
    v_add_f32_dpp v19, v67, v19 quad_perm:[3,3,3,3] row_mask:0xf bank_mask:0xf
    v_add_f32 v88, v88, v19
    s_waitcnt vmcnt(17)
    v_mfma_f32_16x16x32_bf16 v[68:71], v[164:167], v[48:51], v[68:71]
    buffer_load_dwordx4 v[164:167], v252, s[20:23], 0 offen nt
    s_xor_b32 s55, s56, 0x92700
    v_xor_b32 v253, s55, v2
    s_waitcnt vmcnt(17)
    v_mfma_f32_16x16x32_bf16 v[68:71], v[168:171], v[52:55], v[68:71]
    buffer_load_dwordx4 v[168:171], v253, s[20:23], 0 offen nt
    s_xor_b32 s55, s56, 0xe5300
    v_xor_b32 v252, s55, v2
    buffer_load_dwordx4 v[100:103], v5, s[32:35], s57 offen
    s_addk_i32 s57, 0x2000
    buffer_load_dwordx4 v[104:107], v5, s[32:35], s57 offen
    s_addk_i32 s57, 0x2000
    s_waitcnt vmcnt(19)
    v_mfma_f32_16x16x32_bf16 v[64:67], v[172:175], v[40:43], 0
    buffer_load_dwordx4 v[172:175], v252, s[20:23], 0 offen nt
    s_xor_b32 s55, s56, 0xfd000
    v_xor_b32 v253, s55, v2
    s_waitcnt vmcnt(19)
    v_mfma_f32_16x16x32_bf16 v[64:67], v[176:179], v[44:47], v[64:67]
    buffer_load_dwordx4 v[176:179], v253, s[20:23], 0 offen nt
    s_xor_b32 s55, s56, 0x2a700
    v_xor_b32 v252, s55, v2
    v_mov_b32_dpp v89, v68 quad_perm:[0,0,0,0] row_mask:0xf bank_mask:0xf
    v_mov_b32_dpp v19, v70 quad_perm:[2,2,2,2] row_mask:0xf bank_mask:0xf
    s_nop 0
    v_add_f32_dpp v89, v69, v89 quad_perm:[1,1,1,1] row_mask:0xf bank_mask:0xf
    v_add_f32_dpp v19, v71, v19 quad_perm:[3,3,3,3] row_mask:0xf bank_mask:0xf
    v_add_f32 v89, v89, v19
    s_waitcnt vmcnt(19)
    v_mfma_f32_16x16x32_bf16 v[64:67], v[180:183], v[48:51], v[64:67]
    buffer_load_dwordx4 v[180:183], v252, s[20:23], 0 offen nt
    s_xor_b32 s55, s56, 0x32400
    v_xor_b32 v253, s55, v2
    s_waitcnt vmcnt(19)
    v_mfma_f32_16x16x32_bf16 v[64:67], v[184:187], v[52:55], v[64:67]
    buffer_load_dwordx4 v[184:187], v253, s[20:23], 0 offen nt
    s_xor_b32 s55, s56, 0x45000
    v_xor_b32 v252, s55, v2
    buffer_load_dwordx4 v[108:111], v5, s[32:35], s57 offen
    s_addk_i32 s57, 0x2000
    buffer_load_dwordx4 v[112:115], v5, s[32:35], s57 offen
    s_addk_i32 s57, 0x2000
    s_waitcnt vmcnt(21)
    v_mfma_f32_16x16x32_bf16 v[68:71], v[188:191], v[40:43], 0
    buffer_load_dwordx4 v[188:191], v252, s[20:23], 0 offen nt
    s_xor_b32 s55, s56, 0x5d300
    v_xor_b32 v253, s55, v2
    s_waitcnt vmcnt(21)
    v_mfma_f32_16x16x32_bf16 v[68:71], v[192:195], v[44:47], v[68:71]
    buffer_load_dwordx4 v[192:195], v253, s[20:23], 0 offen nt
    s_xor_b32 s55, s56, 0x20e00
    v_xor_b32 v252, s55, v2
    v_mov_b32_dpp v90, v64 quad_perm:[0,0,0,0] row_mask:0xf bank_mask:0xf
    v_mov_b32_dpp v19, v66 quad_perm:[2,2,2,2] row_mask:0xf bank_mask:0xf
    s_nop 0
    v_add_f32_dpp v90, v65, v90 quad_perm:[1,1,1,1] row_mask:0xf bank_mask:0xf
    v_add_f32_dpp v19, v67, v19 quad_perm:[3,3,3,3] row_mask:0xf bank_mask:0xf
    v_add_f32 v90, v90, v19
    s_waitcnt vmcnt(21)
    v_mfma_f32_16x16x32_bf16 v[68:71], v[196:199], v[48:51], v[68:71]
    buffer_load_dwordx4 v[196:199], v252, s[20:23], 0 offen nt
    s_xor_b32 s55, s56, 0x38d00
    v_xor_b32 v253, s55, v2
    s_waitcnt vmcnt(21)
    v_mfma_f32_16x16x32_bf16 v[68:71], v[200:203], v[52:55], v[68:71]
    buffer_load_dwordx4 v[200:203], v253, s[20:23], 0 offen nt
    s_xor_b32 s55, s56, 0x4f900
    v_xor_b32 v252, s55, v2
    buffer_load_dwordx4 v[116:119], v5, s[32:35], s57 offen
    s_addk_i32 s57, 0x2000
    buffer_load_dwordx4 v[120:123], v5, s[32:35], s57 offen
    s_addk_i32 s57, 0x2000
    s_waitcnt vmcnt(23)
    v_mfma_f32_16x16x32_bf16 v[64:67], v[204:207], v[40:43], 0
    buffer_load_dwordx4 v[204:207], v252, s[20:23], 0 offen nt
    s_xor_b32 s55, s56, 0x57a00
    v_xor_b32 v253, s55, v2
    s_waitcnt vmcnt(23)
    v_mfma_f32_16x16x32_bf16 v[64:67], v[208:211], v[44:47], v[64:67]
    buffer_load_dwordx4 v[208:211], v253, s[20:23], 0 offen nt
    s_xor_b32 s55, s56, 0x80d00
    v_xor_b32 v252, s55, v2
    v_mov_b32_dpp v91, v68 quad_perm:[0,0,0,0] row_mask:0xf bank_mask:0xf
    v_mov_b32_dpp v19, v70 quad_perm:[2,2,2,2] row_mask:0xf bank_mask:0xf
    s_nop 0
    v_add_f32_dpp v91, v69, v91 quad_perm:[1,1,1,1] row_mask:0xf bank_mask:0xf
    v_add_f32_dpp v19, v71, v19 quad_perm:[3,3,3,3] row_mask:0xf bank_mask:0xf
    v_add_f32 v91, v91, v19
    s_waitcnt vmcnt(23)
    v_mfma_f32_16x16x32_bf16 v[64:67], v[212:215], v[48:51], v[64:67]
    buffer_load_dwordx4 v[212:215], v252, s[20:23], 0 offen nt
    s_xor_b32 s55, s56, 0x98e00
    v_xor_b32 v253, s55, v2
    s_waitcnt vmcnt(23)
    v_mfma_f32_16x16x32_bf16 v[64:67], v[216:219], v[52:55], v[64:67]
    buffer_load_dwordx4 v[216:219], v253, s[20:23], 0 offen nt
    s_xor_b32 s55, s56, 0xefa00
    v_xor_b32 v252, s55, v2
    buffer_load_dwordx4 v[124:127], v5, s[32:35], s57 offen
    s_addk_i32 s57, 0x2000
    buffer_load_dwordx4 v[128:131], v5, s[32:35], s57 offen
    s_addk_i32 s57, 0x2000
    s_waitcnt vmcnt(25)
    v_mfma_f32_16x16x32_bf16 v[68:71], v[220:223], v[40:43], 0
    buffer_load_dwordx4 v[220:223], v252, s[20:23], 0 offen nt
    s_xor_b32 s55, s56, 0xf7900
    v_xor_b32 v253, s55, v2
    s_waitcnt vmcnt(25)
    v_mfma_f32_16x16x32_bf16 v[68:71], v[224:227], v[44:47], v[68:71]
    buffer_load_dwordx4 v[224:227], v253, s[20:23], 0 offen nt
    v_xor_b32 v252, s48, v2
    v_mov_b32_dpp v92, v64 quad_perm:[0,0,0,0] row_mask:0xf bank_mask:0xf
    v_mov_b32_dpp v19, v66 quad_perm:[2,2,2,2] row_mask:0xf bank_mask:0xf
    s_nop 0
    v_add_f32_dpp v92, v65, v92 quad_perm:[1,1,1,1] row_mask:0xf bank_mask:0xf
    v_add_f32_dpp v19, v67, v19 quad_perm:[3,3,3,3] row_mask:0xf bank_mask:0xf
    v_add_f32 v92, v92, v19
    s_waitcnt vmcnt(25)
    v_mfma_f32_16x16x32_bf16 v[68:71], v[228:231], v[48:51], v[68:71]
    buffer_load_dwordx4 v[228:231], v252, s[20:23], 0 offen nt
    v_xor_b32 v253, s60, v2
    s_waitcnt vmcnt(25)
    v_mfma_f32_16x16x32_bf16 v[68:71], v[232:235], v[52:55], v[68:71]
    buffer_load_dwordx4 v[232:235], v253, s[20:23], 0 offen nt
    v_xor_b32 v252, s56, v3
    buffer_load_dwordx4 v[132:135], v5, s[32:35], s57 offen
    s_addk_i32 s57, 0x2000
    buffer_load_dwordx4 v[136:139], v5, s[32:35], s57 offen
    s_addk_i32 s57, 0x2000
    s_waitcnt vmcnt(27)
    v_mfma_f32_16x16x32_bf16 v[64:67], v[164:167], v[40:43], 0
    s_barrier
    buffer_load_dwordx4 v[164:167], v252, s[24:27], 0 offen nt
    s_xor_b32 s55, s56, 0x18300
    v_xor_b32 v253, s55, v3
    s_waitcnt vmcnt(27)
    v_mfma_f32_16x16x32_bf16 v[64:67], v[168:171], v[44:47], v[64:67]
    buffer_load_dwordx4 v[168:171], v253, s[24:27], 0 offen nt
    s_xor_b32 s55, s56, 0x6f700
    v_xor_b32 v252, s55, v3
    v_mov_b32_dpp v93, v68 quad_perm:[0,0,0,0] row_mask:0xf bank_mask:0xf
    v_mov_b32_dpp v19, v70 quad_perm:[2,2,2,2] row_mask:0xf bank_mask:0xf
    s_nop 0
    v_add_f32_dpp v93, v69, v93 quad_perm:[1,1,1,1] row_mask:0xf bank_mask:0xf
    v_add_f32_dpp v19, v71, v19 quad_perm:[3,3,3,3] row_mask:0xf bank_mask:0xf
    v_add_f32 v93, v93, v19
    s_waitcnt vmcnt(25)
    v_mfma_f32_16x16x32_bf16 v[64:67], v[172:175], v[48:51], v[64:67]
    buffer_load_dwordx4 v[172:175], v252, s[24:27], 0 offen nt
    s_xor_b32 s55, s56, 0x77400
    v_xor_b32 v253, s55, v3
    s_waitcnt vmcnt(25)
    v_mfma_f32_16x16x32_bf16 v[64:67], v[176:179], v[52:55], v[64:67]
    buffer_load_dwordx4 v[176:179], v253, s[24:27], 0 offen nt
    s_xor_b32 s55, s56, 0xa0300
    v_xor_b32 v252, s55, v3
    buffer_load_dwordx4 v[140:143], v5, s[32:35], s57 offen
    s_addk_i32 s57, 0x2000
    buffer_load_dwordx4 v[144:147], v5, s[32:35], s57 offen
    s_addk_i32 s57, 0x2000
    s_waitcnt vmcnt(27)
    v_mfma_f32_16x16x32_bf16 v[68:71], v[180:183], v[40:43], 0
    buffer_load_dwordx4 v[180:183], v252, s[24:27], 0 offen nt
    s_xor_b32 s55, s56, 0xb8000
    v_xor_b32 v253, s55, v3
    s_waitcnt vmcnt(27)
    v_mfma_f32_16x16x32_bf16 v[68:71], v[184:187], v[44:47], v[68:71]
    buffer_load_dwordx4 v[184:187], v253, s[24:27], 0 offen nt
    s_xor_b32 s55, s56, 0xcf400
    v_xor_b32 v252, s55, v3
    v_mov_b32_dpp v94, v64 quad_perm:[0,0,0,0] row_mask:0xf bank_mask:0xf
    v_mov_b32_dpp v19, v66 quad_perm:[2,2,2,2] row_mask:0xf bank_mask:0xf
    s_nop 0
    v_add_f32_dpp v94, v65, v94 quad_perm:[1,1,1,1] row_mask:0xf bank_mask:0xf
    v_add_f32_dpp v19, v67, v19 quad_perm:[3,3,3,3] row_mask:0xf bank_mask:0xf
    v_add_f32 v94, v94, v19
    s_waitcnt vmcnt(25)
    v_mfma_f32_16x16x32_bf16 v[68:71], v[188:191], v[48:51], v[68:71]
    buffer_load_dwordx4 v[188:191], v252, s[24:27], 0 offen nt
    s_xor_b32 s55, s56, 0xd7700
    v_xor_b32 v253, s55, v3
    s_waitcnt vmcnt(25)
    v_mfma_f32_16x16x32_bf16 v[68:71], v[192:195], v[52:55], v[68:71]
    buffer_load_dwordx4 v[192:195], v253, s[24:27], 0 offen nt
    s_xor_b32 s55, s56, 0xaaa00
    v_xor_b32 v252, s55, v3
    buffer_load_dwordx4 v[148:151], v5, s[32:35], s57 offen
    s_addk_i32 s57, 0x2000
    buffer_load_dwordx4 v[152:155], v5, s[32:35], s57 offen
    s_addk_i32 s57, 0x2000
    s_waitcnt vmcnt(27)
    v_mfma_f32_16x16x32_bf16 v[64:67], v[196:199], v[40:43], 0
    buffer_load_dwordx4 v[196:199], v252, s[24:27], 0 offen nt
    s_xor_b32 s55, s56, 0xb2900
    v_xor_b32 v253, s55, v3
    s_waitcnt vmcnt(27)
    v_mfma_f32_16x16x32_bf16 v[64:67], v[200:203], v[44:47], v[64:67]
    buffer_load_dwordx4 v[200:203], v253, s[24:27], 0 offen nt
    s_xor_b32 s55, s56, 0xc5d00
    v_xor_b32 v252, s55, v3
    v_mov_b32_dpp v95, v68 quad_perm:[0,0,0,0] row_mask:0xf bank_mask:0xf
    v_mov_b32_dpp v19, v70 quad_perm:[2,2,2,2] row_mask:0xf bank_mask:0xf
    s_nop 0
    v_add_f32_dpp v95, v69, v95 quad_perm:[1,1,1,1] row_mask:0xf bank_mask:0xf
    v_add_f32_dpp v19, v71, v19 quad_perm:[3,3,3,3] row_mask:0xf bank_mask:0xf
    v_add_f32 v95, v95, v19
    s_waitcnt vmcnt(25)
    v_mfma_f32_16x16x32_bf16 v[64:67], v[204:207], v[48:51], v[64:67]
    buffer_load_dwordx4 v[204:207], v252, s[24:27], 0 offen nt
    s_xor_b32 s55, s56, 0xdde00
    v_xor_b32 v253, s55, v3
    s_waitcnt vmcnt(25)
    v_mfma_f32_16x16x32_bf16 v[64:67], v[208:211], v[52:55], v[64:67]
    buffer_load_dwordx4 v[208:211], v253, s[24:27], 0 offen nt
    s_xor_b32 s55, s56, 0xa900
    v_xor_b32 v252, s55, v3
    buffer_load_dwordx4 v[156:159], v5, s[32:35], s57 offen
    s_addk_i32 s57, 0x2000
    buffer_load_dwordx4 v[160:163], v5, s[32:35], s57 offen
    s_waitcnt vmcnt(27)
    v_mfma_f32_16x16x32_bf16 v[68:71], v[212:215], v[40:43], 0
    buffer_load_dwordx4 v[212:215], v252, s[24:27], 0 offen nt
    s_xor_b32 s55, s56, 0x12a00
    v_xor_b32 v253, s55, v3
    s_waitcnt vmcnt(27)
    v_mfma_f32_16x16x32_bf16 v[68:71], v[216:219], v[44:47], v[68:71]
    buffer_load_dwordx4 v[216:219], v253, s[24:27], 0 offen nt
    s_xor_b32 s55, s65, 0x0
    v_xor_b32 v252, s55, v3
    v_mov_b32_dpp v96, v64 quad_perm:[0,0,0,0] row_mask:0xf bank_mask:0xf
    v_mov_b32_dpp v19, v66 quad_perm:[2,2,2,2] row_mask:0xf bank_mask:0xf
    s_nop 0
    v_add_f32_dpp v96, v65, v96 quad_perm:[1,1,1,1] row_mask:0xf bank_mask:0xf
    v_add_f32_dpp v19, v67, v19 quad_perm:[3,3,3,3] row_mask:0xf bank_mask:0xf
    v_add_f32 v96, v96, v19
    s_waitcnt vmcnt(25)
    v_mfma_f32_16x16x32_bf16 v[68:71], v[220:223], v[48:51], v[68:71]
    buffer_load_dwordx4 v[220:223], v252, s[24:27], 0 offen nt
    s_xor_b32 s55, s56, 0x65e00
    v_xor_b32 v253, s55, v3
    s_waitcnt vmcnt(25)
    v_mfma_f32_16x16x32_bf16 v[68:71], v[224:227], v[52:55], v[68:71]
    buffer_load_dwordx4 v[224:227], v253, s[24:27], 0 offen nt
    s_xor_b32 s55, s56, 0x7dd00
    v_xor_b32 v252, s55, v3
    s_waitcnt vmcnt(25)
    v_mfma_f32_16x16x32_bf16 v[64:67], v[228:231], v[40:43], 0
    buffer_load_dwordx4 v[228:231], v252, s[24:27], 0 offen nt
    s_xor_b32 s55, s56, 0x1ca00
    v_xor_b32 v253, s55, v3
    s_waitcnt vmcnt(25)
    v_mfma_f32_16x16x32_bf16 v[64:67], v[232:235], v[44:47], v[64:67]
    buffer_load_dwordx4 v[232:235], v253, s[24:27], 0 offen nt
    s_xor_b32 s55, s56, 0x4900
    v_xor_b32 v252, s55, v3
    v_mov_b32_dpp v97, v68 quad_perm:[0,0,0,0] row_mask:0xf bank_mask:0xf
    v_mov_b32_dpp v19, v70 quad_perm:[2,2,2,2] row_mask:0xf bank_mask:0xf
    s_nop 0
    v_add_f32_dpp v97, v69, v97 quad_perm:[1,1,1,1] row_mask:0xf bank_mask:0xf
    v_add_f32_dpp v19, v71, v19 quad_perm:[3,3,3,3] row_mask:0xf bank_mask:0xf
    v_add_f32 v97, v97, v19
    v_mov_b32_dpp v98, v64 quad_perm:[0,0,0,0] row_mask:0xf bank_mask:0xf
    v_mov_b32_dpp v19, v66 quad_perm:[2,2,2,2] row_mask:0xf bank_mask:0xf
    s_nop 0
    v_add_f32_dpp v98, v65, v98 quad_perm:[1,1,1,1] row_mask:0xf bank_mask:0xf
    v_add_f32_dpp v19, v67, v19 quad_perm:[3,3,3,3] row_mask:0xf bank_mask:0xf
    v_add_f32 v98, v98, v19
    v_bfe_u32 v12, v1, 2, 2
    v_cmp_gt_u32 vcc, s54, v12
    v_mov_b32 v12, 0xff800000
    s_nop 0
    v_cndmask_b32 v98, v12, v98, vcc
    v_max3_f32 v12, v80, v81, v82
    v_max3_f32 v12, v12, v83, v84
    v_max3_f32 v12, v12, v85, v86
    v_max3_f32 v12, v12, v87, v88
    v_max3_f32 v12, v12, v89, v90
    v_max3_f32 v12, v12, v91, v92
    v_max3_f32 v12, v12, v93, v94
    v_max3_f32 v12, v12, v95, v96
    v_max3_f32 v12, v12, v97, v98
    s_nop 1
    v_max_f32_dpp v12, v12, v12 row_ror:4 row_mask:0xf bank_mask:0xf
    s_nop 1
    v_max_f32_dpp v12, v12, v12 row_ror:8 row_mask:0xf bank_mask:0xf
    s_lshl_b32 s62, s59, 2
    v_mov_b32 v13, s62
    ds_max_f32 v13, v12 offset:18432
    s_waitcnt lgkmcnt(0)
    s_barrier
    ds_read_b32 v12, v13 offset:18432
    s_waitcnt lgkmcnt(0)
    v_mul_f32 v12, s61, v12
    v_fma_f32 v80, v80, s61, -v12
    v_fma_f32 v81, v81, s61, -v12
    v_fma_f32 v82, v82, s61, -v12
    v_fma_f32 v83, v83, s61, -v12
    v_fma_f32 v84, v84, s61, -v12
    v_fma_f32 v85, v85, s61, -v12
    v_fma_f32 v86, v86, s61, -v12
    v_fma_f32 v87, v87, s61, -v12
    v_fma_f32 v88, v88, s61, -v12
    v_fma_f32 v89, v89, s61, -v12
    v_fma_f32 v90, v90, s61, -v12
    v_fma_f32 v91, v91, s61, -v12
    v_fma_f32 v92, v92, s61, -v12
    v_fma_f32 v93, v93, s61, -v12
    v_fma_f32 v94, v94, s61, -v12
    v_fma_f32 v95, v95, s61, -v12
    v_fma_f32 v96, v96, s61, -v12
    v_fma_f32 v97, v97, s61, -v12
    v_fma_f32 v98, v98, s61, -v12
    v_exp_f32 v80, v80
    v_exp_f32 v81, v81
    v_exp_f32 v82, v82
    v_exp_f32 v83, v83
    v_exp_f32 v84, v84
    v_exp_f32 v85, v85
    v_exp_f32 v86, v86
    v_exp_f32 v87, v87
    v_exp_f32 v88, v88
    v_exp_f32 v89, v89
    v_exp_f32 v90, v90
    v_exp_f32 v91, v91
    v_exp_f32 v92, v92
    v_exp_f32 v93, v93
    v_exp_f32 v94, v94
    v_exp_f32 v95, v95
    v_exp_f32 v96, v96
    v_exp_f32 v97, v97
    v_exp_f32 v98, v98
    v_add_f32 v14, v80, v81
    v_add_f32 v14, v14, v82
    v_add_f32 v14, v14, v83
    v_add_f32 v14, v14, v84
    v_add_f32 v14, v14, v85
    v_add_f32 v14, v14, v86
    v_add_f32 v14, v14, v87
    v_add_f32 v14, v14, v88
    v_add_f32 v14, v14, v89
    v_add_f32 v14, v14, v90
    v_add_f32 v14, v14, v91
    v_add_f32 v14, v14, v92
    v_add_f32 v14, v14, v93
    v_add_f32 v14, v14, v94
    v_add_f32 v14, v14, v95
    v_add_f32 v14, v14, v96
    v_add_f32 v14, v14, v97
    v_add_f32 v14, v14, v98
    v_cvt_pk_bf16_f32 v80, v80, v80
    v_cvt_pk_bf16_f32 v81, v81, v81
    v_cvt_pk_bf16_f32 v82, v82, v82
    v_cvt_pk_bf16_f32 v83, v83, v83
    v_cvt_pk_bf16_f32 v84, v84, v84
    v_cvt_pk_bf16_f32 v85, v85, v85
    v_cvt_pk_bf16_f32 v86, v86, v86
    v_cvt_pk_bf16_f32 v87, v87, v87
    v_cvt_pk_bf16_f32 v88, v88, v88
    v_cvt_pk_bf16_f32 v89, v89, v89
    v_cvt_pk_bf16_f32 v90, v90, v90
    v_cvt_pk_bf16_f32 v91, v91, v91
    v_cvt_pk_bf16_f32 v92, v92, v92
    v_cvt_pk_bf16_f32 v93, v93, v93
    v_cvt_pk_bf16_f32 v94, v94, v94
    v_cvt_pk_bf16_f32 v95, v95, v95
    v_cvt_pk_bf16_f32 v96, v96, v96
    v_cvt_pk_bf16_f32 v97, v97, v97
    v_cvt_pk_bf16_f32 v98, v98, v98
    v_add_f32_dpp v14, v14, v14 row_ror:4 row_mask:0xf bank_mask:0xf
    s_nop 1
    v_add_f32_dpp v14, v14, v14 row_ror:8 row_mask:0xf bank_mask:0xf
    v_mul_f32 v14, 0x3d800000, v14
    ds_add_f32 v13, v14 offset:18448
    s_waitcnt lgkmcnt(0)
    s_barrier
    s_mov_b32 s44, 0x05040100
    s_mov_b32 s45, 0x07060302
    v_and_b32_dpp v20, v80, v6 quad_perm:[0,1,2,3] row_mask:0xf bank_mask:0x1
    v_and_b32_dpp v21, v80, v7 quad_perm:[0,1,2,3] row_mask:0xf bank_mask:0x1
    v_and_b32_dpp v22, v80, v6 row_ror:4 row_mask:0xf bank_mask:0x2
    v_and_b32_dpp v23, v80, v7 row_ror:4 row_mask:0xf bank_mask:0x2
    v_and_b32_dpp v24, v80, v6 row_ror:12 row_mask:0xf bank_mask:0x1
    v_and_b32_dpp v25, v80, v7 row_ror:12 row_mask:0xf bank_mask:0x1
    v_and_b32_dpp v26, v80, v6 quad_perm:[0,1,2,3] row_mask:0xf bank_mask:0x2
    v_and_b32_dpp v27, v80, v7 quad_perm:[0,1,2,3] row_mask:0xf bank_mask:0x2
    v_and_b32_dpp v28, v80, v6 row_ror:8 row_mask:0xf bank_mask:0x1
    v_and_b32_dpp v29, v80, v7 row_ror:8 row_mask:0xf bank_mask:0x1
    v_and_b32_dpp v30, v80, v6 row_ror:12 row_mask:0xf bank_mask:0x2
    v_and_b32_dpp v31, v80, v7 row_ror:12 row_mask:0xf bank_mask:0x2
    v_and_b32_dpp v32, v80, v6 row_ror:4 row_mask:0xf bank_mask:0x1
    v_and_b32_dpp v33, v80, v7 row_ror:4 row_mask:0xf bank_mask:0x1
    v_and_b32_dpp v34, v80, v6 row_ror:8 row_mask:0xf bank_mask:0x2
    v_and_b32_dpp v35, v80, v7 row_ror:8 row_mask:0xf bank_mask:0x2
    s_waitcnt vmcnt(23)
    v_mfma_f32_16x16x32_bf16 v[56:59], v[20:23], v[164:167], 0
    buffer_load_dwordx4 v[164:167], v252, s[24:27], 0 offen nt
    s_xor_b32 s55, s56, 0x73d00
    v_xor_b32 v253, s55, v3
    s_waitcnt vmcnt(23)
    v_mfma_f32_16x16x32_bf16 v[56:59], v[24:27], v[168:171], v[56:59]
    buffer_load_dwordx4 v[168:171], v253, s[24:27], 0 offen nt
    s_xor_b32 s55, s56, 0x6be00
    v_xor_b32 v252, s55, v3
    s_waitcnt vmcnt(23)
    v_mfma_f32_16x16x32_bf16 v[56:59], v[28:31], v[172:175], v[56:59]
    buffer_load_dwordx4 v[172:175], v252, s[24:27], 0 offen nt
    s_xor_b32 s55, s65, 0x1ca00
    v_xor_b32 v253, s55, v3
    s_waitcnt vmcnt(23)
    v_mfma_f32_16x16x32_bf16 v[56:59], v[32:35], v[176:179], v[56:59]
    buffer_load_dwordx4 v[176:179], v253, s[24:27], 0 offen nt
    s_xor_b32 s55, s56, 0xbc900
    v_xor_b32 v252, s55, v3
    v_perm_b32 v40, v104, v100, s44
    v_perm_b32 v41, v104, v100, s45
    v_perm_b32 v48, v105, v101, s44
    v_perm_b32 v49, v105, v101, s45
    v_perm_b32 v236, v106, v102, s44
    v_perm_b32 v237, v106, v102, s45
    v_perm_b32 v244, v107, v103, s44
    v_perm_b32 v245, v107, v103, s45
    v_and_b32_dpp v20, v81, v6 quad_perm:[0,1,2,3] row_mask:0xf bank_mask:0x1
    v_and_b32_dpp v21, v81, v7 quad_perm:[0,1,2,3] row_mask:0xf bank_mask:0x1
    v_and_b32_dpp v22, v81, v6 row_ror:4 row_mask:0xf bank_mask:0x2
    v_and_b32_dpp v23, v81, v7 row_ror:4 row_mask:0xf bank_mask:0x2
    v_and_b32_dpp v24, v81, v6 row_ror:12 row_mask:0xf bank_mask:0x1
    v_and_b32_dpp v25, v81, v7 row_ror:12 row_mask:0xf bank_mask:0x1
    v_and_b32_dpp v26, v81, v6 quad_perm:[0,1,2,3] row_mask:0xf bank_mask:0x2
    v_and_b32_dpp v27, v81, v7 quad_perm:[0,1,2,3] row_mask:0xf bank_mask:0x2
    v_and_b32_dpp v28, v81, v6 row_ror:8 row_mask:0xf bank_mask:0x1
    v_and_b32_dpp v29, v81, v7 row_ror:8 row_mask:0xf bank_mask:0x1
    v_and_b32_dpp v30, v81, v6 row_ror:12 row_mask:0xf bank_mask:0x2
    v_and_b32_dpp v31, v81, v7 row_ror:12 row_mask:0xf bank_mask:0x2
    v_and_b32_dpp v32, v81, v6 row_ror:4 row_mask:0xf bank_mask:0x1
    v_and_b32_dpp v33, v81, v7 row_ror:4 row_mask:0xf bank_mask:0x1
    v_and_b32_dpp v34, v81, v6 row_ror:8 row_mask:0xf bank_mask:0x2
    v_and_b32_dpp v35, v81, v7 row_ror:8 row_mask:0xf bank_mask:0x2
    s_waitcnt vmcnt(21)
    v_mfma_f32_16x16x32_bf16 v[56:59], v[20:23], v[180:183], v[56:59]
    buffer_load_dwordx4 v[180:183], v252, s[24:27], 0 offen nt
    s_xor_b32 s55, s56, 0xa4a00
    v_xor_b32 v253, s55, v3
    s_waitcnt vmcnt(21)
    v_mfma_f32_16x16x32_bf16 v[56:59], v[24:27], v[184:187], v[56:59]
    buffer_load_dwordx4 v[184:187], v253, s[24:27], 0 offen nt
    s_xor_b32 s55, s56, 0xd3e00
    v_xor_b32 v252, s55, v3
    s_waitcnt vmcnt(21)
    v_mfma_f32_16x16x32_bf16 v[56:59], v[28:31], v[188:191], v[56:59]
    buffer_load_dwordx4 v[188:191], v252, s[24:27], 0 offen nt
    s_xor_b32 s55, s56, 0xcbd00
    v_xor_b32 v253, s55, v3
    s_waitcnt vmcnt(21)
    v_mfma_f32_16x16x32_bf16 v[56:59], v[32:35], v[192:195], v[56:59]
    buffer_load_dwordx4 v[192:195], v253, s[24:27], 0 offen nt
    s_xor_b32 s55, s65, 0xa0300
    v_xor_b32 v252, s55, v3
    v_perm_b32 v42, v112, v108, s44
    v_perm_b32 v43, v112, v108, s45
    v_perm_b32 v50, v113, v109, s44
    v_perm_b32 v51, v113, v109, s45
    v_perm_b32 v238, v114, v110, s44
    v_perm_b32 v239, v114, v110, s45
    v_perm_b32 v246, v115, v111, s44
    v_perm_b32 v247, v115, v111, s45
    v_and_b32_dpp v20, v82, v6 quad_perm:[0,1,2,3] row_mask:0xf bank_mask:0x1
    v_and_b32_dpp v21, v82, v7 quad_perm:[0,1,2,3] row_mask:0xf bank_mask:0x1
    v_and_b32_dpp v22, v82, v6 row_ror:4 row_mask:0xf bank_mask:0x2
    v_and_b32_dpp v23, v82, v7 row_ror:4 row_mask:0xf bank_mask:0x2
    v_and_b32_dpp v24, v82, v6 row_ror:12 row_mask:0xf bank_mask:0x1
    v_and_b32_dpp v25, v82, v7 row_ror:12 row_mask:0xf bank_mask:0x1
    v_and_b32_dpp v26, v82, v6 quad_perm:[0,1,2,3] row_mask:0xf bank_mask:0x2
    v_and_b32_dpp v27, v82, v7 quad_perm:[0,1,2,3] row_mask:0xf bank_mask:0x2
    v_and_b32_dpp v28, v82, v6 row_ror:8 row_mask:0xf bank_mask:0x1
    v_and_b32_dpp v29, v82, v7 row_ror:8 row_mask:0xf bank_mask:0x1
    v_and_b32_dpp v30, v82, v6 row_ror:12 row_mask:0xf bank_mask:0x2
    v_and_b32_dpp v31, v82, v7 row_ror:12 row_mask:0xf bank_mask:0x2
    v_and_b32_dpp v32, v82, v6 row_ror:4 row_mask:0xf bank_mask:0x1
    v_and_b32_dpp v33, v82, v7 row_ror:4 row_mask:0xf bank_mask:0x1
    v_and_b32_dpp v34, v82, v6 row_ror:8 row_mask:0xf bank_mask:0x2
    v_and_b32_dpp v35, v82, v7 row_ror:8 row_mask:0xf bank_mask:0x2
    s_waitcnt vmcnt(19)
    v_mfma_f32_16x16x32_bf16 v[56:59], v[20:23], v[196:199], v[56:59]
    buffer_load_dwordx4 v[196:199], v252, s[24:27], 0 offen nt
    s_xor_b32 s55, s56, 0xb6000
    v_xor_b32 v253, s55, v3
    s_waitcnt vmcnt(19)
    v_mfma_f32_16x16x32_bf16 v[56:59], v[24:27], v[200:203], v[56:59]
    buffer_load_dwordx4 v[200:203], v253, s[24:27], 0 offen nt
    s_xor_b32 s55, s56, 0xae300
    v_xor_b32 v252, s55, v3
    s_waitcnt vmcnt(19)
    v_mfma_f32_16x16x32_bf16 v[56:59], v[28:31], v[204:207], v[56:59]
    buffer_load_dwordx4 v[204:207], v252, s[24:27], 0 offen nt
    s_xor_b32 s55, s65, 0xbc900
    v_xor_b32 v253, s55, v3
    s_waitcnt vmcnt(19)
    v_mfma_f32_16x16x32_bf16 v[56:59], v[32:35], v[208:211], v[56:59]
    buffer_load_dwordx4 v[208:211], v253, s[24:27], 0 offen nt
    s_xor_b32 s55, s56, 0xd9700
    v_xor_b32 v252, s55, v3
    v_perm_b32 v44, v120, v116, s44
    v_perm_b32 v45, v120, v116, s45
    v_perm_b32 v52, v121, v117, s44
    v_perm_b32 v53, v121, v117, s45
    v_perm_b32 v240, v122, v118, s44
    v_perm_b32 v241, v122, v118, s45
    v_perm_b32 v248, v123, v119, s44
    v_perm_b32 v249, v123, v119, s45
    s_lshl_b32 s62, s59, 9
    v_lshl_add_u32 v15, v1, 2, s62
    v_bfe_u32 v16, v1, 2, 1
    v_lshlrev_b32 v16, 9, v16
    v_bfe_u32 v17, v1, 3, 1
    v_lshl_add_u32 v16, v17, 7, v16
    v_bfe_u32 v17, v1, 4, 1
    v_lshl_add_u32 v16, v17, 6, v16
    v_lshrrev_b32 v17, 5, v1
    v_lshl_add_u32 v16, v17, 4, v16
    s_mul_i32 s63, s58, 96
    s_add_u32 s63, s63, s42
    s_add_u32 s64, s63, 96
    s_and_b32 s46, s43, 1
    s_lshl_b32 s47, s46, 5
    s_add_u32 s63, s63, s47
    s_add_u32 s63, s63, 32
    s_add_u32 s92, s67, 1
    s_add_u32 s93, s68, 1
    s_cmp_eq_u32 s46, 1
    s_cselect_b32 s64, s64, 0x40000
    s_cselect_b32 s98, -1, 0xffff
    s_mov_b32 s99, s98
    s_mul_i32 s67, s67, 0x9e3779b1
    s_add_u32 s67, s67, 0x7f4a7c15
    s_mul_i32 s68, s68, 0x9e3779b1
    s_add_u32 s68, s68, 0x7f4a7c15
    v_mov_b32 v17, s63
    v_mov_b32 v18, s64
    v_mov_b32 v65, s67
    v_mov_b32 v67, s68
    v_and_b32 v12, 16, v1
    v_cmp_eq_u32 vcc, 0, v12
    s_nop 1
    v_cndmask_b32 v17, v18, v17, vcc
    v_cndmask_b32 v65, v67, v65, vcc
    v_mov_b32 v67, v65
    v_mov_b32 v69, v65
    v_mov_b32 v71, v65
    v_lshlrev_b32 v18, 7, v17
    v_and_b32 v12, 7, v1
    v_lshl_add_u32 v18, v12, 4, v18
    v_and_b32 v12, 15, v1
    v_lshlrev_b32 v13, 4, v12
    v_and_b32 v12, 32, v1
    v_lshl_add_u32 v13, v12, 3, v13
    v_lshl_add_u32 v17, v17, 12, v13
    s_lshl_b32 s62, s3, 9
    v_and_b32 v12, 0x1e8, v0
    v_cmp_eq_u32 vcc, 0, v12
    v_mov_b32 v12, 0x8000000
    s_nop 0
    v_cndmask_b32 v18, v12, v18, vcc
    v_bfe_u32 v14, v1, 4, 1
    v_lshlrev_b32 v14, 2, v14
    ds_read_b32 v68, v14 offset:18432
    ds_read_b32 v70, v14 offset:18448
    v_and_b32_dpp v20, v83, v6 quad_perm:[0,1,2,3] row_mask:0xf bank_mask:0x1
    v_and_b32_dpp v21, v83, v7 quad_perm:[0,1,2,3] row_mask:0xf bank_mask:0x1
    v_and_b32_dpp v22, v83, v6 row_ror:4 row_mask:0xf bank_mask:0x2
    v_and_b32_dpp v23, v83, v7 row_ror:4 row_mask:0xf bank_mask:0x2
    v_and_b32_dpp v24, v83, v6 row_ror:12 row_mask:0xf bank_mask:0x1
    v_and_b32_dpp v25, v83, v7 row_ror:12 row_mask:0xf bank_mask:0x1
    v_and_b32_dpp v26, v83, v6 quad_perm:[0,1,2,3] row_mask:0xf bank_mask:0x2
    v_and_b32_dpp v27, v83, v7 quad_perm:[0,1,2,3] row_mask:0xf bank_mask:0x2
    v_and_b32_dpp v28, v83, v6 row_ror:8 row_mask:0xf bank_mask:0x1
    v_and_b32_dpp v29, v83, v7 row_ror:8 row_mask:0xf bank_mask:0x1
    v_and_b32_dpp v30, v83, v6 row_ror:12 row_mask:0xf bank_mask:0x2
    v_and_b32_dpp v31, v83, v7 row_ror:12 row_mask:0xf bank_mask:0x2
    v_and_b32_dpp v32, v83, v6 row_ror:4 row_mask:0xf bank_mask:0x1
    v_and_b32_dpp v33, v83, v7 row_ror:4 row_mask:0xf bank_mask:0x1
    v_and_b32_dpp v34, v83, v6 row_ror:8 row_mask:0xf bank_mask:0x2
    v_and_b32_dpp v35, v83, v7 row_ror:8 row_mask:0xf bank_mask:0x2
    s_waitcnt vmcnt(17)
    v_mfma_f32_16x16x32_bf16 v[56:59], v[20:23], v[212:215], v[56:59]
    buffer_load_dwordx4 v[212:215], v252, s[24:27], 0 offen nt
    s_xor_b32 s55, s56, 0xc1400
    v_xor_b32 v253, s55, v3
    s_waitcnt vmcnt(17)
    v_mfma_f32_16x16x32_bf16 v[56:59], v[24:27], v[216:219], v[56:59]
    buffer_load_dwordx4 v[216:219], v253, s[24:27], 0 offen nt
    s_xor_b32 s55, s56, 0x16300
    v_xor_b32 v252, s55, v3
    s_waitcnt vmcnt(17)
    v_mfma_f32_16x16x32_bf16 v[56:59], v[28:31], v[220:223], v[56:59]
    buffer_load_dwordx4 v[220:223], v252, s[24:27], 0 offen nt
    s_xor_b32 s55, s56, 0xe000
    v_xor_b32 v253, s55, v3
    s_waitcnt vmcnt(17)
    v_mfma_f32_16x16x32_bf16 v[56:59], v[32:35], v[224:227], v[56:59]
    buffer_load_dwordx4 v[224:227], v253, s[24:27], 0 offen nt
    s_xor_b32 s55, s56, 0x79400
    v_xor_b32 v252, s55, v3
    v_perm_b32 v46, v128, v124, s44
    v_perm_b32 v47, v128, v124, s45
    v_perm_b32 v54, v129, v125, s44
    v_perm_b32 v55, v129, v125, s45
    v_perm_b32 v242, v130, v126, s44
    v_perm_b32 v243, v130, v126, s45
    v_perm_b32 v250, v131, v127, s44
    v_perm_b32 v251, v131, v127, s45
    s_waitcnt lgkmcnt(0)
    s_mov_b32 s63, 1589248
    v_mul_f32 v68, s61, v68
    buffer_store_dwordx4 v[68:71], v18, s[36:39], s63 offen sc1
    s_mov_b32 s63, 1585152
    v_and_b32_dpp v20, v84, v6 quad_perm:[0,1,2,3] row_mask:0xf bank_mask:0x1
    v_and_b32_dpp v21, v84, v7 quad_perm:[0,1,2,3] row_mask:0xf bank_mask:0x1
    v_and_b32_dpp v22, v84, v6 row_ror:4 row_mask:0xf bank_mask:0x2
    v_and_b32_dpp v23, v84, v7 row_ror:4 row_mask:0xf bank_mask:0x2
    v_and_b32_dpp v24, v84, v6 row_ror:12 row_mask:0xf bank_mask:0x1
    v_and_b32_dpp v25, v84, v7 row_ror:12 row_mask:0xf bank_mask:0x1
    v_and_b32_dpp v26, v84, v6 quad_perm:[0,1,2,3] row_mask:0xf bank_mask:0x2
    v_and_b32_dpp v27, v84, v7 quad_perm:[0,1,2,3] row_mask:0xf bank_mask:0x2
    v_and_b32_dpp v28, v84, v6 row_ror:8 row_mask:0xf bank_mask:0x1
    v_and_b32_dpp v29, v84, v7 row_ror:8 row_mask:0xf bank_mask:0x1
    v_and_b32_dpp v30, v84, v6 row_ror:12 row_mask:0xf bank_mask:0x2
    v_and_b32_dpp v31, v84, v7 row_ror:12 row_mask:0xf bank_mask:0x2
    v_and_b32_dpp v32, v84, v6 row_ror:4 row_mask:0xf bank_mask:0x1
    v_and_b32_dpp v33, v84, v7 row_ror:4 row_mask:0xf bank_mask:0x1
    v_and_b32_dpp v34, v84, v6 row_ror:8 row_mask:0xf bank_mask:0x2
    v_and_b32_dpp v35, v84, v7 row_ror:8 row_mask:0xf bank_mask:0x2
    s_waitcnt vmcnt(17)
    v_mfma_f32_16x16x32_bf16 v[56:59], v[20:23], v[228:231], v[56:59]
    buffer_load_dwordx4 v[228:231], v252, s[24:27], 0 offen nt
    s_xor_b32 s55, s56, 0x61700
    v_xor_b32 v253, s55, v3
    s_waitcnt vmcnt(17)
    v_mfma_f32_16x16x32_bf16 v[56:59], v[24:27], v[232:235], v[56:59]
    buffer_load_dwordx4 v[232:235], v253, s[24:27], 0 offen nt
    s_xor_b32 s55, s65, 0x96e00
    v_xor_b32 v252, s55, v3
    s_waitcnt vmcnt(17)
    v_mfma_f32_16x16x32_bf16 v[56:59], v[28:31], v[164:167], v[56:59]
    buffer_load_dwordx4 v[164:167], v252, s[24:27], 0 offen nt
    s_xor_b32 s55, s65, 0x8a400
    v_xor_b32 v253, s55, v3
    s_waitcnt vmcnt(17)
    v_mfma_f32_16x16x32_bf16 v[56:59], v[32:35], v[168:171], v[56:59]
    buffer_load_dwordx4 v[168:171], v253, s[24:27], 0 offen nt
    s_xor_b32 s55, s65, 0x36d00
    v_xor_b32 v252, s55, v3
    v_and_b32_dpp v20, v85, v6 quad_perm:[0,1,2,3] row_mask:0xf bank_mask:0x1
    v_and_b32_dpp v21, v85, v7 quad_perm:[0,1,2,3] row_mask:0xf bank_mask:0x1
    v_and_b32_dpp v22, v85, v6 row_ror:4 row_mask:0xf bank_mask:0x2
    v_and_b32_dpp v23, v85, v7 row_ror:4 row_mask:0xf bank_mask:0x2
    v_and_b32_dpp v24, v85, v6 row_ror:12 row_mask:0xf bank_mask:0x1
    v_and_b32_dpp v25, v85, v7 row_ror:12 row_mask:0xf bank_mask:0x1
    v_and_b32_dpp v26, v85, v6 quad_perm:[0,1,2,3] row_mask:0xf bank_mask:0x2
    v_and_b32_dpp v27, v85, v7 quad_perm:[0,1,2,3] row_mask:0xf bank_mask:0x2
    v_and_b32_dpp v28, v85, v6 row_ror:8 row_mask:0xf bank_mask:0x1
    v_and_b32_dpp v29, v85, v7 row_ror:8 row_mask:0xf bank_mask:0x1
    v_and_b32_dpp v30, v85, v6 row_ror:12 row_mask:0xf bank_mask:0x2
    v_and_b32_dpp v31, v85, v7 row_ror:12 row_mask:0xf bank_mask:0x2
    v_and_b32_dpp v32, v85, v6 row_ror:4 row_mask:0xf bank_mask:0x1
    v_and_b32_dpp v33, v85, v7 row_ror:4 row_mask:0xf bank_mask:0x1
    v_and_b32_dpp v34, v85, v6 row_ror:8 row_mask:0xf bank_mask:0x2
    v_and_b32_dpp v35, v85, v7 row_ror:8 row_mask:0xf bank_mask:0x2
    s_waitcnt vmcnt(17)
    v_mfma_f32_16x16x32_bf16 v[56:59], v[20:23], v[172:175], v[56:59]
    buffer_load_dwordx4 v[172:175], v252, s[24:27], 0 offen nt
    s_xor_b32 s55, s56, 0x96e00
    v_xor_b32 v253, s55, v3
    s_waitcnt vmcnt(17)
    v_mfma_f32_16x16x32_bf16 v[56:59], v[24:27], v[176:179], v[56:59]
    buffer_load_dwordx4 v[176:179], v253, s[24:27], 0 offen nt
    s_xor_b32 s55, s56, 0x8ed00
    v_xor_b32 v252, s55, v3
    s_waitcnt vmcnt(17)
    v_mfma_f32_16x16x32_bf16 v[56:59], v[28:31], v[180:183], v[56:59]
    buffer_load_dwordx4 v[180:183], v252, s[24:27], 0 offen nt
    s_xor_b32 s55, s56, 0xf9900
    v_xor_b32 v253, s55, v3
    s_waitcnt vmcnt(17)
    v_mfma_f32_16x16x32_bf16 v[56:59], v[32:35], v[184:187], v[56:59]
    buffer_load_dwordx4 v[184:187], v253, s[24:27], 0 offen nt
    s_xor_b32 s55, s56, 0xe1a00
    v_xor_b32 v252, s55, v3
    v_and_b32_dpp v20, v86, v6 quad_perm:[0,1,2,3] row_mask:0xf bank_mask:0x1
    v_and_b32_dpp v21, v86, v7 quad_perm:[0,1,2,3] row_mask:0xf bank_mask:0x1
    v_and_b32_dpp v22, v86, v6 row_ror:4 row_mask:0xf bank_mask:0x2
    v_and_b32_dpp v23, v86, v7 row_ror:4 row_mask:0xf bank_mask:0x2
    v_and_b32_dpp v24, v86, v6 row_ror:12 row_mask:0xf bank_mask:0x1
    v_and_b32_dpp v25, v86, v7 row_ror:12 row_mask:0xf bank_mask:0x1
    v_and_b32_dpp v26, v86, v6 quad_perm:[0,1,2,3] row_mask:0xf bank_mask:0x2
    v_and_b32_dpp v27, v86, v7 quad_perm:[0,1,2,3] row_mask:0xf bank_mask:0x2
    v_and_b32_dpp v28, v86, v6 row_ror:8 row_mask:0xf bank_mask:0x1
    v_and_b32_dpp v29, v86, v7 row_ror:8 row_mask:0xf bank_mask:0x1
    v_and_b32_dpp v30, v86, v6 row_ror:12 row_mask:0xf bank_mask:0x2
    v_and_b32_dpp v31, v86, v7 row_ror:12 row_mask:0xf bank_mask:0x2
    v_and_b32_dpp v32, v86, v6 row_ror:4 row_mask:0xf bank_mask:0x1
    v_and_b32_dpp v33, v86, v7 row_ror:4 row_mask:0xf bank_mask:0x1
    v_and_b32_dpp v34, v86, v6 row_ror:8 row_mask:0xf bank_mask:0x2
    v_and_b32_dpp v35, v86, v7 row_ror:8 row_mask:0xf bank_mask:0x2
    s_waitcnt vmcnt(17)
    v_mfma_f32_16x16x32_bf16 v[56:59], v[20:23], v[188:191], v[56:59]
    buffer_load_dwordx4 v[188:191], v252, s[24:27], 0 offen nt
    s_xor_b32 s55, s56, 0x36d00
    v_xor_b32 v253, s55, v3
    s_waitcnt vmcnt(17)
    v_mfma_f32_16x16x32_bf16 v[56:59], v[24:27], v[192:195], v[56:59]
    buffer_load_dwordx4 v[192:195], v253, s[24:27], 0 offen nt
    s_xor_b32 s55, s56, 0x2ee00
    v_xor_b32 v252, s55, v3
    s_waitcnt vmcnt(17)
    v_mfma_f32_16x16x32_bf16 v[56:59], v[28:31], v[196:199], v[56:59]
    buffer_load_dwordx4 v[196:199], v252, s[24:27], 0 offen nt
    s_xor_b32 s55, s56, 0x59a00
    v_xor_b32 v253, s55, v3
    s_waitcnt vmcnt(17)
    v_mfma_f32_16x16x32_bf16 v[56:59], v[32:35], v[200:203], v[56:59]
    buffer_load_dwordx4 v[200:203], v253, s[24:27], 0 offen nt
    s_xor_b32 s55, s56, 0x41900
    v_xor_b32 v252, s55, v3
    v_perm_b32 v100, v136, v132, s44
    v_perm_b32 v101, v136, v132, s45
    v_perm_b32 v108, v137, v133, s44
    v_perm_b32 v109, v137, v133, s45
    v_perm_b32 v116, v138, v134, s44
    v_perm_b32 v117, v138, v134, s45
    v_perm_b32 v124, v139, v135, s44
    v_perm_b32 v125, v139, v135, s45
    v_and_b32_dpp v20, v87, v6 quad_perm:[0,1,2,3] row_mask:0xf bank_mask:0x1
    v_and_b32_dpp v21, v87, v7 quad_perm:[0,1,2,3] row_mask:0xf bank_mask:0x1
    v_and_b32_dpp v22, v87, v6 row_ror:4 row_mask:0xf bank_mask:0x2
    v_and_b32_dpp v23, v87, v7 row_ror:4 row_mask:0xf bank_mask:0x2
    v_and_b32_dpp v24, v87, v6 row_ror:12 row_mask:0xf bank_mask:0x1
    v_and_b32_dpp v25, v87, v7 row_ror:12 row_mask:0xf bank_mask:0x1
    v_and_b32_dpp v26, v87, v6 quad_perm:[0,1,2,3] row_mask:0xf bank_mask:0x2
    v_and_b32_dpp v27, v87, v7 quad_perm:[0,1,2,3] row_mask:0xf bank_mask:0x2
    v_and_b32_dpp v28, v87, v6 row_ror:8 row_mask:0xf bank_mask:0x1
    v_and_b32_dpp v29, v87, v7 row_ror:8 row_mask:0xf bank_mask:0x1
    v_and_b32_dpp v30, v87, v6 row_ror:12 row_mask:0xf bank_mask:0x2
    v_and_b32_dpp v31, v87, v7 row_ror:12 row_mask:0xf bank_mask:0x2
    v_and_b32_dpp v32, v87, v6 row_ror:4 row_mask:0xf bank_mask:0x1
    v_and_b32_dpp v33, v87, v7 row_ror:4 row_mask:0xf bank_mask:0x1
    v_and_b32_dpp v34, v87, v6 row_ror:8 row_mask:0xf bank_mask:0x2
    v_and_b32_dpp v35, v87, v7 row_ror:8 row_mask:0xf bank_mask:0x2
    s_waitcnt vmcnt(17)
    v_mfma_f32_16x16x32_bf16 v[56:59], v[20:23], v[204:207], v[56:59]
    buffer_load_dwordx4 v[204:207], v252, s[24:27], 0 offen nt
    s_xor_b32 s55, s56, 0x3c400
    v_xor_b32 v253, s55, v3
    s_waitcnt vmcnt(17)
    v_mfma_f32_16x16x32_bf16 v[56:59], v[24:27], v[208:211], v[56:59]
    buffer_load_dwordx4 v[208:211], v253, s[24:27], 0 offen nt
    s_xor_b32 s55, s56, 0x24700
    v_xor_b32 v252, s55, v3
    s_waitcnt vmcnt(17)
    v_mfma_f32_16x16x32_bf16 v[56:59], v[28:31], v[212:215], v[56:59]
    buffer_load_dwordx4 v[212:215], v252, s[24:27], 0 offen nt
    s_xor_b32 s55, s65, 0x2a700
    v_xor_b32 v253, s55, v3
    s_waitcnt vmcnt(17)
    v_mfma_f32_16x16x32_bf16 v[56:59], v[32:35], v[216:219], v[56:59]
    buffer_load_dwordx4 v[216:219], v253, s[24:27], 0 offen nt
    s_xor_b32 s55, s56, 0x53300
    v_xor_b32 v252, s55, v3
    v_perm_b32 v102, v144, v140, s44
    v_perm_b32 v103, v144, v140, s45
    v_perm_b32 v110, v145, v141, s44
    v_perm_b32 v111, v145, v141, s45
    v_perm_b32 v118, v146, v142, s44
    v_perm_b32 v119, v146, v142, s45
    v_perm_b32 v126, v147, v143, s44
    v_perm_b32 v127, v147, v143, s45
    v_and_b32_dpp v20, v88, v6 quad_perm:[0,1,2,3] row_mask:0xf bank_mask:0x1
    v_and_b32_dpp v21, v88, v7 quad_perm:[0,1,2,3] row_mask:0xf bank_mask:0x1
    v_and_b32_dpp v22, v88, v6 row_ror:4 row_mask:0xf bank_mask:0x2
    v_and_b32_dpp v23, v88, v7 row_ror:4 row_mask:0xf bank_mask:0x2
    v_and_b32_dpp v24, v88, v6 row_ror:12 row_mask:0xf bank_mask:0x1
    v_and_b32_dpp v25, v88, v7 row_ror:12 row_mask:0xf bank_mask:0x1
    v_and_b32_dpp v26, v88, v6 quad_perm:[0,1,2,3] row_mask:0xf bank_mask:0x2
    v_and_b32_dpp v27, v88, v7 quad_perm:[0,1,2,3] row_mask:0xf bank_mask:0x2
    v_and_b32_dpp v28, v88, v6 row_ror:8 row_mask:0xf bank_mask:0x1
    v_and_b32_dpp v29, v88, v7 row_ror:8 row_mask:0xf bank_mask:0x1
    v_and_b32_dpp v30, v88, v6 row_ror:12 row_mask:0xf bank_mask:0x2
    v_and_b32_dpp v31, v88, v7 row_ror:12 row_mask:0xf bank_mask:0x2
    v_and_b32_dpp v32, v88, v6 row_ror:4 row_mask:0xf bank_mask:0x1
    v_and_b32_dpp v33, v88, v7 row_ror:4 row_mask:0xf bank_mask:0x1
    v_and_b32_dpp v34, v88, v6 row_ror:8 row_mask:0xf bank_mask:0x2
    v_and_b32_dpp v35, v88, v7 row_ror:8 row_mask:0xf bank_mask:0x2
    s_waitcnt vmcnt(17)
    v_mfma_f32_16x16x32_bf16 v[56:59], v[20:23], v[220:223], v[56:59]
    buffer_load_dwordx4 v[220:223], v252, s[24:27], 0 offen nt
    s_xor_b32 s55, s56, 0x4b000
    v_xor_b32 v253, s55, v3
    s_waitcnt vmcnt(17)
    v_mfma_f32_16x16x32_bf16 v[56:59], v[24:27], v[224:227], v[56:59]
    buffer_load_dwordx4 v[224:227], v253, s[24:27], 0 offen nt
    s_xor_b32 s55, s56, 0x9c700
    v_xor_b32 v252, s55, v3
    s_waitcnt vmcnt(17)
    v_mfma_f32_16x16x32_bf16 v[56:59], v[28:31], v[228:231], v[56:59]
    buffer_load_dwordx4 v[228:231], v252, s[24:27], 0 offen nt
    s_xor_b32 s55, s56, 0x84400
    v_xor_b32 v253, s55, v3
    s_waitcnt vmcnt(17)
    v_mfma_f32_16x16x32_bf16 v[56:59], v[32:35], v[232:235], v[56:59]
    buffer_load_dwordx4 v[232:235], v253, s[24:27], 0 offen nt
    s_xor_b32 s55, s56, 0xf3000
    v_xor_b32 v252, s55, v3
    v_perm_b32 v104, v152, v148, s44
    v_perm_b32 v105, v152, v148, s45
    v_perm_b32 v112, v153, v149, s44
    v_perm_b32 v113, v153, v149, s45
    v_perm_b32 v120, v154, v150, s44
    v_perm_b32 v121, v154, v150, s45
    v_perm_b32 v128, v155, v151, s44
    v_perm_b32 v129, v155, v151, s45
    v_and_b32_dpp v20, v89, v6 quad_perm:[0,1,2,3] row_mask:0xf bank_mask:0x1
    v_and_b32_dpp v21, v89, v7 quad_perm:[0,1,2,3] row_mask:0xf bank_mask:0x1
    v_and_b32_dpp v22, v89, v6 row_ror:4 row_mask:0xf bank_mask:0x2
    v_and_b32_dpp v23, v89, v7 row_ror:4 row_mask:0xf bank_mask:0x2
    v_and_b32_dpp v24, v89, v6 row_ror:12 row_mask:0xf bank_mask:0x1
    v_and_b32_dpp v25, v89, v7 row_ror:12 row_mask:0xf bank_mask:0x1
    v_and_b32_dpp v26, v89, v6 quad_perm:[0,1,2,3] row_mask:0xf bank_mask:0x2
    v_and_b32_dpp v27, v89, v7 quad_perm:[0,1,2,3] row_mask:0xf bank_mask:0x2
    v_and_b32_dpp v28, v89, v6 row_ror:8 row_mask:0xf bank_mask:0x1
    v_and_b32_dpp v29, v89, v7 row_ror:8 row_mask:0xf bank_mask:0x1
    v_and_b32_dpp v30, v89, v6 row_ror:12 row_mask:0xf bank_mask:0x2
    v_and_b32_dpp v31, v89, v7 row_ror:12 row_mask:0xf bank_mask:0x2
    v_and_b32_dpp v32, v89, v6 row_ror:4 row_mask:0xf bank_mask:0x1
    v_and_b32_dpp v33, v89, v7 row_ror:4 row_mask:0xf bank_mask:0x1
    v_and_b32_dpp v34, v89, v6 row_ror:8 row_mask:0xf bank_mask:0x2
    v_and_b32_dpp v35, v89, v7 row_ror:8 row_mask:0xf bank_mask:0x2
    s_waitcnt vmcnt(17)
    v_mfma_f32_16x16x32_bf16 v[56:59], v[20:23], v[164:167], v[56:59]
    buffer_load_dwordx4 v[164:167], v252, s[24:27], 0 offen nt
    s_xor_b32 s55, s56, 0xeb300
    v_xor_b32 v253, s55, v3
    s_waitcnt vmcnt(17)
    v_mfma_f32_16x16x32_bf16 v[56:59], v[24:27], v[168:171], v[56:59]
    buffer_load_dwordx4 v[168:171], v253, s[24:27], 0 offen nt
    s_xor_b32 s55, s56, 0x8a400
    v_xor_b32 v252, s55, v3
    s_waitcnt vmcnt(17)
    v_mfma_f32_16x16x32_bf16 v[56:59], v[28:31], v[172:175], v[56:59]
    buffer_load_dwordx4 v[172:175], v252, s[24:27], 0 offen nt
    s_xor_b32 s55, s56, 0x92700
    v_xor_b32 v253, s55, v3
    s_waitcnt vmcnt(17)
    v_mfma_f32_16x16x32_bf16 v[56:59], v[32:35], v[176:179], v[56:59]
    buffer_load_dwordx4 v[176:179], v253, s[24:27], 0 offen nt
    s_xor_b32 s55, s56, 0xe5300
    v_xor_b32 v252, s55, v3
    v_perm_b32 v106, v160, v156, s44
    v_perm_b32 v107, v160, v156, s45
    v_perm_b32 v114, v161, v157, s44
    v_perm_b32 v115, v161, v157, s45
    v_perm_b32 v122, v162, v158, s44
    v_perm_b32 v123, v162, v158, s45
    v_perm_b32 v130, v163, v159, s44
    v_perm_b32 v131, v163, v159, s45
    v_and_b32_dpp v20, v90, v6 quad_perm:[0,1,2,3] row_mask:0xf bank_mask:0x1
    v_and_b32_dpp v21, v90, v7 quad_perm:[0,1,2,3] row_mask:0xf bank_mask:0x1
    v_and_b32_dpp v22, v90, v6 row_ror:4 row_mask:0xf bank_mask:0x2
    v_and_b32_dpp v23, v90, v7 row_ror:4 row_mask:0xf bank_mask:0x2
    v_and_b32_dpp v24, v90, v6 row_ror:12 row_mask:0xf bank_mask:0x1
    v_and_b32_dpp v25, v90, v7 row_ror:12 row_mask:0xf bank_mask:0x1
    v_and_b32_dpp v26, v90, v6 quad_perm:[0,1,2,3] row_mask:0xf bank_mask:0x2
    v_and_b32_dpp v27, v90, v7 quad_perm:[0,1,2,3] row_mask:0xf bank_mask:0x2
    v_and_b32_dpp v28, v90, v6 row_ror:8 row_mask:0xf bank_mask:0x1
    v_and_b32_dpp v29, v90, v7 row_ror:8 row_mask:0xf bank_mask:0x1
    v_and_b32_dpp v30, v90, v6 row_ror:12 row_mask:0xf bank_mask:0x2
    v_and_b32_dpp v31, v90, v7 row_ror:12 row_mask:0xf bank_mask:0x2
    v_and_b32_dpp v32, v90, v6 row_ror:4 row_mask:0xf bank_mask:0x1
    v_and_b32_dpp v33, v90, v7 row_ror:4 row_mask:0xf bank_mask:0x1
    v_and_b32_dpp v34, v90, v6 row_ror:8 row_mask:0xf bank_mask:0x2
    v_and_b32_dpp v35, v90, v7 row_ror:8 row_mask:0xf bank_mask:0x2
    s_waitcnt vmcnt(17)
    v_mfma_f32_16x16x32_bf16 v[56:59], v[20:23], v[180:183], v[56:59]
    buffer_load_dwordx4 v[180:183], v252, s[24:27], 0 offen nt
    s_xor_b32 s55, s56, 0xfd000
    v_xor_b32 v253, s55, v3
    s_waitcnt vmcnt(17)
    v_mfma_f32_16x16x32_bf16 v[56:59], v[24:27], v[184:187], v[56:59]
    buffer_load_dwordx4 v[184:187], v253, s[24:27], 0 offen nt
    s_xor_b32 s55, s56, 0x2a700
    v_xor_b32 v252, s55, v3
    s_waitcnt vmcnt(17)
    v_mfma_f32_16x16x32_bf16 v[56:59], v[28:31], v[188:191], v[56:59]
    buffer_load_dwordx4 v[188:191], v252, s[24:27], 0 offen nt
    s_xor_b32 s55, s56, 0x32400
    v_xor_b32 v253, s55, v3
    s_waitcnt vmcnt(17)
    v_mfma_f32_16x16x32_bf16 v[56:59], v[32:35], v[192:195], v[56:59]
    buffer_load_dwordx4 v[192:195], v253, s[24:27], 0 offen nt
    s_xor_b32 s55, s56, 0x45000
    v_xor_b32 v252, s55, v3
    s_mov_b32 s16, s90
    s_and_b32 s17, s91, 0xffff
    s_mov_b32 s18, 0x2000
    s_mov_b32 s19, 0x00020000
    v_bfe_u32 v132, v1, 4, 1
    v_cmp_eq_u32 vcc, 1, v132
    v_add_u32 v132, s58, v132
    v_mov_b32 v139, s92
    v_mov_b32 v140, s93
    v_cndmask_b32 v139, v139, v140, vcc
    v_mul_u32_u24 v157, 96, v132
    v_add_u32 v157, s42, v157
    v_lshlrev_b32 v157, 7, v157
    s_mov_b32 s4, 0x184000
    s_mov_b32 s5, 0x185000
    s_mov_b32 s6, 0x186000
    s_lshl_b32 s46, s3, 7
    s_add_u32 s46, s46, 12288
    v_lshl_add_u32 v158, v132, 10, s46
    s_mov_b32 s63, 1572864
    buffer_load_dwordx4 v[144:147], v157, s[36:39], s4 offen sc1
    buffer_load_dwordx4 v[148:151], v157, s[36:39], s5 offen sc1
    buffer_load_dwordx4 v[152:155], v157, s[36:39], s6 offen sc1
    buffer_load_dword v156, v158, s[36:39], s63 offen sc1
    v_cmp_eq_u32 s[94:95], 0, v132
    v_cmp_eq_u32 s[96:97], 3, v132
    v_mov_b32 v134, 0x1b0000
    v_bfe_u32 v12, v1, 0, 4
    v_lshl_or_b32 v134, v12, 3, v134
    v_bfe_u32 v12, v1, 5, 1
    v_lshl_or_b32 v134, v12, 7, v134
    v_bfe_u32 v12, v132, 0, 2
    v_lshl_or_b32 v134, v12, 12, v134
    v_and_b32 v12, 7, v1
    v_lshlrev_b32 v12, 4, v12
    v_lshl_add_u32 v135, v132, 11, v12
    v_lshrrev_b32 v12, 5, v1
    v_lshl_add_u32 v135, v12, 3, v135
    v_bfe_u32 v12, v1, 3, 1
    v_lshl_add_u32 v135, v12, 2, v135
    s_or_b64 vcc, s[94:95], s[96:97]
    v_mov_b32 v138, 0x60
    v_cndmask_b32 v138, v138, 64, vcc
    v_add_u32 v136, 7, v138
    v_lshlrev_b32 v140, 2, v132
    v_add_u32 v140, 0x182000, v140
    v_mov_b32 v143, 0x8000000
    s_mov_b32 s64, 0
    s_bfe_u32 s46, s3, 0x30000
    s_lshl_b32 s46, s46, 9
    s_or_b32 s64, s64, s46
    s_mov_b32 s46, 0x4b800000
    s_mov_b32 s47, 0xffffc000
    s_mov_b32 s50, 0x2f800000
    s_mov_b32 s51, 0x76ffffff
    v_and_b32 v12, 0x40000000, v17
    v_or_b32 v134, v134, v12
    v_and_b32 v12, 0x1ef, v0
    v_lshlrev_b32 v12, 22, v12
    v_add_u32 v140, v140, v12
    v_cmp_eq_u32 vcc, 0, v12
    v_subrev_u32 v12, 8, v136
    s_nop 0
    v_cndmask_b32 v136, v12, v136, vcc
    v_and_b32_dpp v20, v91, v6 quad_perm:[0,1,2,3] row_mask:0xf bank_mask:0x1
    v_and_b32_dpp v21, v91, v7 quad_perm:[0,1,2,3] row_mask:0xf bank_mask:0x1
    v_and_b32_dpp v22, v91, v6 row_ror:4 row_mask:0xf bank_mask:0x2
    v_and_b32_dpp v23, v91, v7 row_ror:4 row_mask:0xf bank_mask:0x2
    v_and_b32_dpp v24, v91, v6 row_ror:12 row_mask:0xf bank_mask:0x1
    v_and_b32_dpp v25, v91, v7 row_ror:12 row_mask:0xf bank_mask:0x1
    v_and_b32_dpp v26, v91, v6 quad_perm:[0,1,2,3] row_mask:0xf bank_mask:0x2
    v_and_b32_dpp v27, v91, v7 quad_perm:[0,1,2,3] row_mask:0xf bank_mask:0x2
    v_and_b32_dpp v28, v91, v6 row_ror:8 row_mask:0xf bank_mask:0x1
    v_and_b32_dpp v29, v91, v7 row_ror:8 row_mask:0xf bank_mask:0x1
    v_and_b32_dpp v30, v91, v6 row_ror:12 row_mask:0xf bank_mask:0x2
    v_and_b32_dpp v31, v91, v7 row_ror:12 row_mask:0xf bank_mask:0x2
    v_and_b32_dpp v32, v91, v6 row_ror:4 row_mask:0xf bank_mask:0x1
    v_and_b32_dpp v33, v91, v7 row_ror:4 row_mask:0xf bank_mask:0x1
    v_and_b32_dpp v34, v91, v6 row_ror:8 row_mask:0xf bank_mask:0x2
    v_and_b32_dpp v35, v91, v7 row_ror:8 row_mask:0xf bank_mask:0x2
    s_waitcnt vmcnt(21)
    v_mfma_f32_16x16x32_bf16 v[56:59], v[20:23], v[196:199], v[56:59]
    buffer_load_dwordx4 v[196:199], v252, s[24:27], 0 offen nt
    s_xor_b32 s55, s56, 0x5d300
    v_xor_b32 v253, s55, v3
    s_waitcnt vmcnt(21)
    v_mfma_f32_16x16x32_bf16 v[56:59], v[24:27], v[200:203], v[56:59]
    buffer_load_dwordx4 v[200:203], v253, s[24:27], 0 offen nt
    s_xor_b32 s55, s56, 0x20e00
    v_xor_b32 v252, s55, v3
    s_waitcnt vmcnt(21)
    v_mfma_f32_16x16x32_bf16 v[56:59], v[28:31], v[204:207], v[56:59]
    buffer_load_dwordx4 v[204:207], v252, s[24:27], 0 offen nt
    s_xor_b32 s55, s56, 0x38d00
    v_xor_b32 v253, s55, v3
    s_waitcnt vmcnt(21)
    v_mfma_f32_16x16x32_bf16 v[56:59], v[32:35], v[208:211], v[56:59]
    buffer_load_dwordx4 v[208:211], v253, s[24:27], 0 offen nt
    s_xor_b32 s55, s56, 0x4f900
    v_xor_b32 v252, s55, v3
    v_and_b32_dpp v20, v92, v6 quad_perm:[0,1,2,3] row_mask:0xf bank_mask:0x1
    v_and_b32_dpp v21, v92, v7 quad_perm:[0,1,2,3] row_mask:0xf bank_mask:0x1
    v_and_b32_dpp v22, v92, v6 row_ror:4 row_mask:0xf bank_mask:0x2
    v_and_b32_dpp v23, v92, v7 row_ror:4 row_mask:0xf bank_mask:0x2
    v_and_b32_dpp v24, v92, v6 row_ror:12 row_mask:0xf bank_mask:0x1
    v_and_b32_dpp v25, v92, v7 row_ror:12 row_mask:0xf bank_mask:0x1
    v_and_b32_dpp v26, v92, v6 quad_perm:[0,1,2,3] row_mask:0xf bank_mask:0x2
    v_and_b32_dpp v27, v92, v7 quad_perm:[0,1,2,3] row_mask:0xf bank_mask:0x2
    v_and_b32_dpp v28, v92, v6 row_ror:8 row_mask:0xf bank_mask:0x1
    v_and_b32_dpp v29, v92, v7 row_ror:8 row_mask:0xf bank_mask:0x1
    v_and_b32_dpp v30, v92, v6 row_ror:12 row_mask:0xf bank_mask:0x2
    v_and_b32_dpp v31, v92, v7 row_ror:12 row_mask:0xf bank_mask:0x2
    v_and_b32_dpp v32, v92, v6 row_ror:4 row_mask:0xf bank_mask:0x1
    v_and_b32_dpp v33, v92, v7 row_ror:4 row_mask:0xf bank_mask:0x1
    v_and_b32_dpp v34, v92, v6 row_ror:8 row_mask:0xf bank_mask:0x2
    v_and_b32_dpp v35, v92, v7 row_ror:8 row_mask:0xf bank_mask:0x2
    s_waitcnt vmcnt(21)
    v_mfma_f32_16x16x32_bf16 v[56:59], v[20:23], v[212:215], v[56:59]
    buffer_load_dwordx4 v[212:215], v252, s[24:27], 0 offen nt
    s_xor_b32 s55, s56, 0x57a00
    v_xor_b32 v253, s55, v3
    s_waitcnt vmcnt(21)
    v_mfma_f32_16x16x32_bf16 v[56:59], v[24:27], v[216:219], v[56:59]
    buffer_load_dwordx4 v[216:219], v253, s[24:27], 0 offen nt
    s_xor_b32 s55, s56, 0x80d00
    v_xor_b32 v252, s55, v3
    s_waitcnt vmcnt(21)
    v_mfma_f32_16x16x32_bf16 v[56:59], v[28:31], v[220:223], v[56:59]
    buffer_load_dwordx4 v[220:223], v252, s[24:27], 0 offen nt
    s_xor_b32 s55, s56, 0x98e00
    v_xor_b32 v253, s55, v3
    s_waitcnt vmcnt(21)
    v_mfma_f32_16x16x32_bf16 v[56:59], v[32:35], v[224:227], v[56:59]
    buffer_load_dwordx4 v[224:227], v253, s[24:27], 0 offen nt
    s_xor_b32 s55, s56, 0xefa00
    v_xor_b32 v252, s55, v3
    v_and_b32_dpp v20, v93, v6 quad_perm:[0,1,2,3] row_mask:0xf bank_mask:0x1
    v_and_b32_dpp v21, v93, v7 quad_perm:[0,1,2,3] row_mask:0xf bank_mask:0x1
    v_and_b32_dpp v22, v93, v6 row_ror:4 row_mask:0xf bank_mask:0x2
    v_and_b32_dpp v23, v93, v7 row_ror:4 row_mask:0xf bank_mask:0x2
    v_and_b32_dpp v24, v93, v6 row_ror:12 row_mask:0xf bank_mask:0x1
    v_and_b32_dpp v25, v93, v7 row_ror:12 row_mask:0xf bank_mask:0x1
    v_and_b32_dpp v26, v93, v6 quad_perm:[0,1,2,3] row_mask:0xf bank_mask:0x2
    v_and_b32_dpp v27, v93, v7 quad_perm:[0,1,2,3] row_mask:0xf bank_mask:0x2
    v_and_b32_dpp v28, v93, v6 row_ror:8 row_mask:0xf bank_mask:0x1
    v_and_b32_dpp v29, v93, v7 row_ror:8 row_mask:0xf bank_mask:0x1
    v_and_b32_dpp v30, v93, v6 row_ror:12 row_mask:0xf bank_mask:0x2
    v_and_b32_dpp v31, v93, v7 row_ror:12 row_mask:0xf bank_mask:0x2
    v_and_b32_dpp v32, v93, v6 row_ror:4 row_mask:0xf bank_mask:0x1
    v_and_b32_dpp v33, v93, v7 row_ror:4 row_mask:0xf bank_mask:0x1
    v_and_b32_dpp v34, v93, v6 row_ror:8 row_mask:0xf bank_mask:0x2
    v_and_b32_dpp v35, v93, v7 row_ror:8 row_mask:0xf bank_mask:0x2
    s_waitcnt vmcnt(21)
    v_mfma_f32_16x16x32_bf16 v[56:59], v[20:23], v[228:231], v[56:59]
    buffer_load_dwordx4 v[228:231], v252, s[24:27], 0 offen nt
    s_xor_b32 s55, s56, 0xf7900
    v_xor_b32 v253, s55, v3
    s_waitcnt vmcnt(21)
    v_mfma_f32_16x16x32_bf16 v[56:59], v[24:27], v[232:235], v[56:59]
    buffer_load_dwordx4 v[232:235], v253, s[24:27], 0 offen nt
    v_xor_b32 v252, s48, v3
    s_waitcnt vmcnt(21)
    v_mfma_f32_16x16x32_bf16 v[56:59], v[28:31], v[164:167], v[56:59]
    buffer_load_dwordx4 v[164:167], v252, s[24:27], 0 offen nt
    v_xor_b32 v253, s60, v3
    s_waitcnt vmcnt(21)
    v_mfma_f32_16x16x32_bf16 v[56:59], v[32:35], v[168:171], v[56:59]
    buffer_load_dwordx4 v[168:171], v253, s[24:27], 0 offen nt
    v_and_b32_dpp v20, v94, v6 quad_perm:[0,1,2,3] row_mask:0xf bank_mask:0x1
    v_and_b32_dpp v21, v94, v7 quad_perm:[0,1,2,3] row_mask:0xf bank_mask:0x1
    v_and_b32_dpp v22, v94, v6 row_ror:4 row_mask:0xf bank_mask:0x2
    v_and_b32_dpp v23, v94, v7 row_ror:4 row_mask:0xf bank_mask:0x2
    v_and_b32_dpp v24, v94, v6 row_ror:12 row_mask:0xf bank_mask:0x1
    v_and_b32_dpp v25, v94, v7 row_ror:12 row_mask:0xf bank_mask:0x1
    v_and_b32_dpp v26, v94, v6 quad_perm:[0,1,2,3] row_mask:0xf bank_mask:0x2
    v_and_b32_dpp v27, v94, v7 quad_perm:[0,1,2,3] row_mask:0xf bank_mask:0x2
    v_and_b32_dpp v28, v94, v6 row_ror:8 row_mask:0xf bank_mask:0x1
    v_and_b32_dpp v29, v94, v7 row_ror:8 row_mask:0xf bank_mask:0x1
    v_and_b32_dpp v30, v94, v6 row_ror:12 row_mask:0xf bank_mask:0x2
    v_and_b32_dpp v31, v94, v7 row_ror:12 row_mask:0xf bank_mask:0x2
    v_and_b32_dpp v32, v94, v6 row_ror:4 row_mask:0xf bank_mask:0x1
    v_and_b32_dpp v33, v94, v7 row_ror:4 row_mask:0xf bank_mask:0x1
    v_and_b32_dpp v34, v94, v6 row_ror:8 row_mask:0xf bank_mask:0x2
    v_and_b32_dpp v35, v94, v7 row_ror:8 row_mask:0xf bank_mask:0x2
    s_waitcnt vmcnt(21)
    v_mfma_f32_16x16x32_bf16 v[56:59], v[20:23], v[172:175], v[56:59]
    s_waitcnt vmcnt(20)
    v_mfma_f32_16x16x32_bf16 v[56:59], v[24:27], v[176:179], v[56:59]
    s_waitcnt vmcnt(19)
    v_mfma_f32_16x16x32_bf16 v[56:59], v[28:31], v[180:183], v[56:59]
    s_waitcnt vmcnt(18)
    v_mfma_f32_16x16x32_bf16 v[56:59], v[32:35], v[184:187], v[56:59]
    v_and_b32_dpp v20, v95, v6 quad_perm:[0,1,2,3] row_mask:0xf bank_mask:0x1
    v_and_b32_dpp v21, v95, v7 quad_perm:[0,1,2,3] row_mask:0xf bank_mask:0x1
    v_and_b32_dpp v22, v95, v6 row_ror:4 row_mask:0xf bank_mask:0x2
    v_and_b32_dpp v23, v95, v7 row_ror:4 row_mask:0xf bank_mask:0x2
    v_and_b32_dpp v24, v95, v6 row_ror:12 row_mask:0xf bank_mask:0x1
    v_and_b32_dpp v25, v95, v7 row_ror:12 row_mask:0xf bank_mask:0x1
    v_and_b32_dpp v26, v95, v6 quad_perm:[0,1,2,3] row_mask:0xf bank_mask:0x2
    v_and_b32_dpp v27, v95, v7 quad_perm:[0,1,2,3] row_mask:0xf bank_mask:0x2
    v_and_b32_dpp v28, v95, v6 row_ror:8 row_mask:0xf bank_mask:0x1
    v_and_b32_dpp v29, v95, v7 row_ror:8 row_mask:0xf bank_mask:0x1
    v_and_b32_dpp v30, v95, v6 row_ror:12 row_mask:0xf bank_mask:0x2
    v_and_b32_dpp v31, v95, v7 row_ror:12 row_mask:0xf bank_mask:0x2
    v_and_b32_dpp v32, v95, v6 row_ror:4 row_mask:0xf bank_mask:0x1
    v_and_b32_dpp v33, v95, v7 row_ror:4 row_mask:0xf bank_mask:0x1
    v_and_b32_dpp v34, v95, v6 row_ror:8 row_mask:0xf bank_mask:0x2
    v_and_b32_dpp v35, v95, v7 row_ror:8 row_mask:0xf bank_mask:0x2
    s_waitcnt vmcnt(17)
    v_mfma_f32_16x16x32_bf16 v[56:59], v[20:23], v[188:191], v[56:59]
    v_and_b32_dpp v20, v96, v6 quad_perm:[0,1,2,3] row_mask:0xf bank_mask:0x1
    v_and_b32_dpp v21, v96, v7 quad_perm:[0,1,2,3] row_mask:0xf bank_mask:0x1
    v_and_b32_dpp v22, v96, v6 row_ror:4 row_mask:0xf bank_mask:0x2
    v_and_b32_dpp v23, v96, v7 row_ror:4 row_mask:0xf bank_mask:0x2
    s_waitcnt vmcnt(16)
    v_mfma_f32_16x16x32_bf16 v[56:59], v[24:27], v[192:195], v[56:59]
    v_and_b32_dpp v24, v96, v6 row_ror:12 row_mask:0xf bank_mask:0x1
    v_and_b32_dpp v25, v96, v7 row_ror:12 row_mask:0xf bank_mask:0x1
    v_and_b32_dpp v26, v96, v6 quad_perm:[0,1,2,3] row_mask:0xf bank_mask:0x2
    v_and_b32_dpp v27, v96, v7 quad_perm:[0,1,2,3] row_mask:0xf bank_mask:0x2
    s_waitcnt vmcnt(11)
    v_mfma_f32_16x16x32_bf16 v[56:59], v[28:31], v[196:199], v[56:59]
    v_and_b32_dpp v28, v96, v6 row_ror:8 row_mask:0xf bank_mask:0x1
    v_and_b32_dpp v29, v96, v7 row_ror:8 row_mask:0xf bank_mask:0x1
    v_and_b32_dpp v30, v96, v6 row_ror:12 row_mask:0xf bank_mask:0x2
    v_and_b32_dpp v31, v96, v7 row_ror:12 row_mask:0xf bank_mask:0x2
    s_waitcnt vmcnt(10)
    v_mfma_f32_16x16x32_bf16 v[56:59], v[32:35], v[200:203], v[56:59]
    v_and_b32_dpp v32, v96, v6 row_ror:4 row_mask:0xf bank_mask:0x1
    v_and_b32_dpp v33, v96, v7 row_ror:4 row_mask:0xf bank_mask:0x1
    v_and_b32_dpp v34, v96, v6 row_ror:8 row_mask:0xf bank_mask:0x2
    v_and_b32_dpp v35, v96, v7 row_ror:8 row_mask:0xf bank_mask:0x2
    s_mov_b32 s84, 400000
L_chkA:
    v_mov_b32 v161, 0xff800000
    v_cndmask_b32 v144, v144, v161, s[94:95]
    v_cndmask_b32 v145, v145, v65, s[94:95]
    v_cndmask_b32 v146, v146, 0, s[94:95]
    v_cndmask_b32 v147, v147, v65, s[94:95]
    v_cndmask_b32 v152, v152, v161, s[96:97]
    v_cndmask_b32 v153, v153, v65, s[96:97]
    v_cndmask_b32 v154, v154, 0, s[96:97]
    v_cndmask_b32 v155, v155, v65, s[96:97]
    v_min3_u32 v161, v145, v147, v156
    v_min3_u32 v161, v161, v149, v151
    v_min3_u32 v161, v161, v153, v155
    v_max3_u32 v162, v145, v147, v156
    v_max3_u32 v162, v162, v149, v151
    v_max3_u32 v162, v162, v153, v155
    v_cmp_ne_u32 vcc, v65, v161
    v_cmp_ne_u32 s[88:89], v65, v162
    s_nop 0
    s_or_b64 vcc, vcc, s[88:89]
    s_and_b64 vcc, vcc, s[98:99]
    s_cbranch_scc1 L_retryA
L_okA:
    v_max3_f32 v161, v144, v148, v152
    v_sub_f32 v144, v144, v161
    v_sub_f32 v148, v148, v161
    v_sub_f32 v152, v152, v161
    v_sub_f32 v141, v68, v161
    v_exp_f32 v144, v144
    v_exp_f32 v148, v148
    v_exp_f32 v152, v152
    v_exp_f32 v141, v141
    v_mul_f32 v161, v144, v146
    v_fmac_f32 v161, v148, v150
    v_fmac_f32 v161, v152, v154
    v_rcp_f32 v161, v161
    v_mul_f32 v141, 0x4c800000, v141
    v_mul_f32 v141, v141, v161
    v_cndmask_b32 v141, 0, v141, s[98:99]
    s_mov_b32 s46, 0x89000000
    s_mov_b32 s51, 0x20000000
    s_mov_b32 s49, 0x32800000
    s_mov_b32 s50, 0x22800000
    v_cvt_f32_u32 v142, v136
    v_mul_f32 v142, 0xa2800000, v142
    s_mov_b64 s[88:89], 0
    s_mov_b64 s[90:91], 0
    v_mov_b32 v144, 0
    v_mov_b32 v145, 0
    v_mov_b32 v148, 0
    v_mov_b32 v149, 0
    v_mov_b32 v152, 0
    v_mov_b32 v153, 0
    v_mov_b32 v156, 0
    v_mov_b32 v157, 0
    v_bfe_i32 v133, v1, 0, 1
    v_and_b32 v133, 0xaaaa, v133
    v_or_b32 v133, 0x4444, v133
    s_waitcnt vmcnt(9)
    v_mfma_f32_16x16x32_bf16 v[56:59], v[20:23], v[204:207], v[56:59]
    v_and_b32_dpp v20, v97, v6 quad_perm:[0,1,2,3] row_mask:0xf bank_mask:0x1
    v_and_b32_dpp v21, v97, v7 quad_perm:[0,1,2,3] row_mask:0xf bank_mask:0x1
    v_and_b32_dpp v22, v97, v6 row_ror:4 row_mask:0xf bank_mask:0x2
    v_and_b32_dpp v23, v97, v7 row_ror:4 row_mask:0xf bank_mask:0x2
    s_waitcnt vmcnt(8)
    v_mfma_f32_16x16x32_bf16 v[56:59], v[24:27], v[208:211], v[56:59]
    v_and_b32_dpp v24, v97, v6 row_ror:12 row_mask:0xf bank_mask:0x1
    v_and_b32_dpp v25, v97, v7 row_ror:12 row_mask:0xf bank_mask:0x1
    v_and_b32_dpp v26, v97, v6 quad_perm:[0,1,2,3] row_mask:0xf bank_mask:0x2
    v_and_b32_dpp v27, v97, v7 quad_perm:[0,1,2,3] row_mask:0xf bank_mask:0x2
    s_waitcnt vmcnt(7)
    v_mfma_f32_16x16x32_bf16 v[56:59], v[28:31], v[212:215], v[56:59]
    v_and_b32_dpp v28, v97, v6 row_ror:8 row_mask:0xf bank_mask:0x1
    v_and_b32_dpp v29, v97, v7 row_ror:8 row_mask:0xf bank_mask:0x1
    v_and_b32_dpp v30, v97, v6 row_ror:12 row_mask:0xf bank_mask:0x2
    v_and_b32_dpp v31, v97, v7 row_ror:12 row_mask:0xf bank_mask:0x2
    s_waitcnt vmcnt(6)
    v_mfma_f32_16x16x32_bf16 v[56:59], v[32:35], v[216:219], v[56:59]
    v_and_b32_dpp v32, v97, v6 row_ror:4 row_mask:0xf bank_mask:0x1
    v_and_b32_dpp v33, v97, v7 row_ror:4 row_mask:0xf bank_mask:0x1
    v_and_b32_dpp v34, v97, v6 row_ror:8 row_mask:0xf bank_mask:0x2
    v_and_b32_dpp v35, v97, v7 row_ror:8 row_mask:0xf bank_mask:0x2
    s_waitcnt vmcnt(5)
    v_mfma_f32_16x16x32_bf16 v[56:59], v[20:23], v[220:223], v[56:59]
    v_and_b32_dpp v20, v98, v6 quad_perm:[0,1,2,3] row_mask:0xf bank_mask:0x1
    v_and_b32_dpp v21, v98, v7 quad_perm:[0,1,2,3] row_mask:0xf bank_mask:0x1
    v_and_b32_dpp v22, v98, v6 row_ror:4 row_mask:0xf bank_mask:0x2
    v_and_b32_dpp v23, v98, v7 row_ror:4 row_mask:0xf bank_mask:0x2
    s_waitcnt vmcnt(4)
    v_mfma_f32_16x16x32_bf16 v[56:59], v[24:27], v[224:227], v[56:59]
    v_and_b32_dpp v24, v98, v6 row_ror:12 row_mask:0xf bank_mask:0x1
    v_and_b32_dpp v25, v98, v7 row_ror:12 row_mask:0xf bank_mask:0x1
    v_and_b32_dpp v26, v98, v6 quad_perm:[0,1,2,3] row_mask:0xf bank_mask:0x2
    v_and_b32_dpp v27, v98, v7 quad_perm:[0,1,2,3] row_mask:0xf bank_mask:0x2
    s_waitcnt vmcnt(3)
    v_mfma_f32_16x16x32_bf16 v[56:59], v[28:31], v[228:231], v[56:59]
    s_waitcnt vmcnt(2)
    v_mfma_f32_16x16x32_bf16 v[56:59], v[32:35], v[232:235], v[56:59]
    s_waitcnt vmcnt(1)
    v_mfma_f32_16x16x32_bf16 v[56:59], v[20:23], v[164:167], v[56:59]
    s_waitcnt vmcnt(0)
    v_mfma_f32_16x16x32_bf16 v[56:59], v[24:27], v[168:171], v[56:59]
    s_nop 7
    v_permlane32_swap_b32 v56, v57
    v_permlane32_swap_b32 v58, v59
    ds_add_f32 v15, v56 offset:16384
    ds_add_f32 v15, v58 offset:16640
    s_waitcnt lgkmcnt(0)
    s_barrier
    ds_read_b128 v[80:83], v16 offset:16384
    ds_read_b128 v[84:87], v16 offset:16640
    ds_read_b128 v[88:91], v16 offset:16416
    ds_read_b128 v[92:95], v16 offset:16672
    s_waitcnt lgkmcnt(2)
    v_cvt_pk_bf16_f32 v72, v80, v81
    v_cvt_pk_bf16_f32 v73, v82, v83
    v_cvt_pk_bf16_f32 v74, v84, v85
    v_cvt_pk_bf16_f32 v75, v86, v87
    s_nop 1
    v_smfmac_f32_16x16x64_bf16 v[144:147], v[72:75], v[40:47], v133
    v_smfmac_f32_16x16x64_bf16 v[152:155], v[72:75], v[236:243], v133
    s_waitcnt lgkmcnt(0)
    v_cvt_pk_bf16_f32 v76, v88, v89
    v_cvt_pk_bf16_f32 v77, v90, v91
    v_cvt_pk_bf16_f32 v78, v92, v93
    v_cvt_pk_bf16_f32 v79, v94, v95
    v_smfmac_f32_16x16x64_bf16 v[148:151], v[72:75], v[48:55], v133
    v_smfmac_f32_16x16x64_bf16 v[156:159], v[72:75], v[244:251], v133
    v_smfmac_f32_16x16x64_bf16 v[144:147], v[76:79], v[100:107], v133
    v_smfmac_f32_16x16x64_bf16 v[152:155], v[76:79], v[116:123], v133
    v_smfmac_f32_16x16x64_bf16 v[148:151], v[76:79], v[108:115], v133
    v_smfmac_f32_16x16x64_bf16 v[156:159], v[76:79], v[124:131], v133
    s_nop 5
    v_permlane32_swap_b32 v144, v152
    v_permlane32_swap_b32 v145, v153
    v_permlane32_swap_b32 v148, v156
    v_permlane32_swap_b32 v149, v157
    v_add_f32_dpp v64, v152, v144 row_ror:8 row_mask:0xf bank_mask:0x3
    v_add_f32_dpp v66, v153, v145 row_ror:8 row_mask:0xf bank_mask:0x3
    s_nop 0
    v_add_f32_dpp v64, v148, v156 row_ror:8 row_mask:0xf bank_mask:0xc
    v_add_f32_dpp v66, v149, v157 row_ror:8 row_mask:0xf bank_mask:0xc
    v_mul_f32 v84, v64, v141
    v_mul_f32 v85, v66, v141
    v_fract_f32 v80, v84
    v_fract_f32 v82, v85
    v_lshl_add_u32 v90, v84, 1, s46
    v_lshl_add_u32 v91, v85, 1, s46
    v_mul_f32 v80, 0x4f800000, v80
    v_mul_f32 v82, 0x4f800000, v82
    v_max_u32 v88, v90, v91
    v_cvt_u32_f32 v80, v80
    v_cvt_u32_f32 v82, v82
    v_cmp_le_u32 vcc, s51, v88
    v_cvt_flr_i32_f32 v81, v84
    v_cvt_flr_i32_f32 v83, v85
    s_and_b64 vcc, vcc, s[98:99]
    v_and_or_b32 v80, v80, s47, 1
    v_and_or_b32 v82, v82, s47, 1
    s_cbranch_scc1 L_excA
L_addA:
    buffer_atomic_add_x2 v[80:81], v134, s[36:39], s64 offen offset:0 sc0 sc1
    buffer_atomic_add_x2 v[82:83], v134, s[36:39], s64 offen offset:256 sc0 sc1
    v_fma_f32 v90, v84, s49, v142
    v_fma_f32 v91, v85, s49, v142
    s_waitcnt vmcnt(0)
    v_cvt_f32_u32 v86, v80
    v_cvt_f32_u32 v87, v82
    v_cvt_f32_i32 v88, v81
    v_cvt_f32_i32 v89, v83
    v_and_b32 v92, 0x7f, v80
    v_and_b32 v93, 0x7f, v82
    v_fma_f32 v86, v86, s50, v90
    v_fma_f32 v87, v87, s50, v91
    v_cmp_eq_u32 s[92:93], v92, v136
    v_cmp_eq_u32 s[94:95], v93, v136
    v_fma_f32 v86, v88, s49, v86
    v_fma_f32 v87, v89, s49, v87
    s_and_b64 vcc, s[92:93], s[94:95]
    v_cvt_pk_bf16_f32 v90, v86, v87
    v_cndmask_b32 v92, v143, v135, vcc
    buffer_store_dword v90, v92, s[16:19], s52 offen sc1
    v_cndmask_b32 v140, v143, v140, s[92:93]
    buffer_store_dword v139, v140, s[36:39], 0 offen sc1
    v_and_b32 v86, 0x3f80, v80
    v_and_b32 v87, 0x3f80, v82
    v_cmp_ne_u32 vcc, 0, v86
    v_cmp_ne_u32 s[96:97], 0, v87
    s_xor_b64 s[86:87], s[92:93], s[94:95]
    s_or_b64 vcc, vcc, s[88:89]
    s_or_b64 s[96:97], s[96:97], s[90:91]
    s_and_b64 vcc, vcc, s[92:93]
    s_and_b64 s[96:97], s[96:97], s[94:95]
    s_or_b64 s[96:97], s[96:97], vcc
    s_or_b64 s[86:87], s[86:87], s[96:97]
    s_cbranch_scc1 L_finA
L_endA:
    s_endpgm
L_retryA:
    s_nop 7
    buffer_load_dwordx4 v[144:147], v157, s[36:39], s4 offen sc1
    buffer_load_dwordx4 v[148:151], v157, s[36:39], s5 offen sc1
    buffer_load_dwordx4 v[152:155], v157, s[36:39], s6 offen sc1
    buffer_load_dword v156, v158, s[36:39], s63 offen sc1
    s_waitcnt vmcnt(0)
    s_sub_u32 s84, s84, 1
    s_cbranch_scc0 L_chkA
    s_branch L_okA
L_excA:
    s_nop 7
    v_cmp_le_u32 s[88:89], s51, v90
    v_cmp_le_u32 s[90:91], s51, v91
    v_cmp_ne_u32 s[92:93], s46, v90
    v_cmp_ne_u32 s[94:95], s46, v91
    v_mul_f32 v88, s49, v141
    v_mov_b32 v89, 0x81
    s_and_b64 s[88:89], s[88:89], s[98:99]
    s_and_b64 s[90:91], s[90:91], s[98:99]
    s_and_b64 s[88:89], s[88:89], s[92:93]
    s_and_b64 s[90:91], s[90:91], s[94:95]
    s_or_b64 s[96:97], s[88:89], s[90:91]
    s_cbranch_scc0 L_addA
    v_mul_f32 v90, v64, v88
    v_mul_f32 v91, v66, v88
    v_cndmask_b32 v92, v143, v134, s[88:89]
    v_cndmask_b32 v93, v143, v134, s[90:91]
    s_add_u32 s84, s64, 0x8000
    buffer_atomic_add_f32 v90, v92, s[36:39], s84 offen offset:0 sc1
    buffer_atomic_add_f32 v91, v93, s[36:39], s84 offen offset:256 sc1
    v_cndmask_b32 v80, v80, v89, s[88:89]
    v_cndmask_b32 v81, v81, 0, s[88:89]
    v_cndmask_b32 v84, v84, 0, s[88:89]
    v_cndmask_b32 v82, v82, v89, s[90:91]
    v_cndmask_b32 v83, v83, 0, s[90:91]
    v_cndmask_b32 v85, v85, 0, s[90:91]
    s_waitcnt vmcnt(0)
    s_branch L_addA
L_finA:
    s_nop 7
    v_cndmask_b32 v92, v143, v135, s[92:93]
    v_cndmask_b32 v93, v143, v135, s[94:95]
    buffer_store_short v90, v92, s[16:19], s52 offen sc1
    buffer_store_short_d16_hi v90, v93, s[16:19], s52 offen offset:2 sc1
    s_cmp_eq_u64 s[96:97], 0
    s_cbranch_scc1 L_endA
    s_add_u32 s84, s64, 0x8000
    buffer_load_dword v64, v134, s[36:39], s84 offen offset:0 sc1
    buffer_load_dword v66, v134, s[36:39], s84 offen offset:256 sc1
    v_and_b32 v86, s47, v80
    v_and_b32 v87, s47, v82
    v_cvt_f32_u32 v86, v86
    v_cvt_f32_u32 v87, v87
    v_mul_f32 v84, s49, v84
    v_mul_f32 v85, s49, v85
    v_fma_f32 v86, v86, s50, v84
    v_fma_f32 v87, v87, s50, v85
    v_fma_f32 v86, v88, s49, v86
    v_fma_f32 v87, v89, s49, v87
    s_waitcnt vmcnt(0)
    v_add_f32 v86, v86, v64
    v_add_f32 v87, v87, v66
    v_cndmask_b32 v92, v143, v135, s[92:93]
    v_cndmask_b32 v93, v143, v135, s[94:95]
    v_cvt_pk_bf16_f32 v90, v86, v87
    buffer_store_short v90, v92, s[16:19], s52 offen sc1
    buffer_store_short_d16_hi v90, v93, s[16:19], s52 offen offset:2 sc1
    s_branch L_endA
L_exit:
    s_waitcnt lgkmcnt(0)
    s_endpgm
.p2align 6
L_pathB:
    s_load_dwordx4 s[20:23], s[0:1], 40
    s_load_dwordx4 s[8:11], s[0:1], 56
    s_load_dwordx2 s[12:13], s[0:1], 72
    v_lshrrev_b32 v12, 6, v0
    v_and_b32 v1, 63, v0
    v_readfirstlane_b32 s3, v12
    v_lshrrev_b32 v12, 4, v1
    v_bfe_u32 v13, v1, 3, 1
    v_and_b32 v14, 7, v1
    v_lshlrev_b32 v4, 21, v13
    v_lshl_add_u32 v4, v12, 19, v4
    v_lshl_add_u32 v4, v14, 4, v4
    v_lshlrev_b32 v16, 9, v13
    v_lshl_add_u32 v16, v12, 7, v16
    s_lshl_b32 s52, s40, 10
    s_lshl_b32 s53, s41, 10
    s_lshl_b32 s54, s3, 7
    s_add_u32 s58, s53, s54
    s_and_b32 s60, s40, 3
    s_lshl_b32 s59, s60, 17
    s_add_u32 s53, s58, s59
    s_lshl_b32 s63, s60, 5
    v_bfe_i32 v254, v1, 4, 1
    v_and_b32 v255, 0x24000, v254
    v_xor_b32 v4, v4, v255
    v_xor_b32 v4, s59, v4
    v_and_b32 v255, 32, v254
    v_xor_b32 v16, v16, v255
    v_xor_b32 v16, s63, v16
    s_waitcnt lgkmcnt(0)
    s_mov_b64 s[4:5], s[20:21]
    s_mov_b64 s[6:7], s[22:23]
    s_cmp_eq_u32 s3, 7
    s_cbranch_scc1 L_initB
L_initB_ret:
    s_mov_b32 s16, s4
    s_and_b32 s17, s5, 0xffff
    s_mov_b32 s18, 0x1000
    s_mov_b32 s19, 0x00020000
    s_mov_b32 s28, s10
    s_and_b32 s29, s11, 0xffff
    s_mov_b32 s30, 0x400000
    s_mov_b32 s31, 0x00020000
    buffer_load_dwordx4 v[72:75], v16, s[16:19], s52 offen offset:0
    buffer_load_dwordx4 v[136:139], v4, s[28:31], s58 offen
    v_xor_b32 v253, 0x2000, v4
    buffer_load_dwordx4 v[140:143], v253, s[28:31], s58 offen
    v_xor_b32 v252, 0x4000, v4
    buffer_load_dwordx4 v[144:147], v252, s[28:31], s58 offen
    v_xor_b32 v253, 0x6000, v4
    buffer_load_dwordx4 v[148:151], v253, s[28:31], s58 offen
    buffer_load_dwordx4 v[76:79], v16, s[16:19], s52 offen offset:16
    v_xor_b32 v255, 32, v16
    buffer_load_dwordx4 v[80:83], v255, s[16:19], s52 offen offset:0
    buffer_load_dwordx4 v[84:87], v255, s[16:19], s52 offen offset:16
    v_xor_b32 v254, 64, v16
    buffer_load_dwordx4 v[88:91], v254, s[16:19], s52 offen offset:0
    buffer_load_dwordx4 v[92:95], v254, s[16:19], s52 offen offset:16
    v_xor_b32 v255, 96, v16
    buffer_load_dwordx4 v[96:99], v255, s[16:19], s52 offen offset:0
    buffer_load_dwordx4 v[100:103], v255, s[16:19], s52 offen offset:16
    v_xor_b32 v252, 0x8000, v4
    buffer_load_dwordx4 v[152:155], v252, s[28:31], s58 offen
    v_xor_b32 v253, 0xa000, v4
    buffer_load_dwordx4 v[156:159], v253, s[28:31], s58 offen
    v_xor_b32 v252, 0xc000, v4
    buffer_load_dwordx4 v[160:163], v252, s[28:31], s58 offen
    v_xor_b32 v253, 0xe000, v4
    buffer_load_dwordx4 v[164:167], v253, s[28:31], s58 offen
    s_lshl_b32 s47, s40, 23
    s_lshl_b32 s50, s41, 20
    s_add_u32 s47, s47, s50
    s_add_u32 s47, s47, 786432
    s_add_u32 s20, s6, s47
    s_addc_u32 s21, s7, 0
    s_and_b32 s21, s21, 0xffff
    s_mov_b32 s22, 0x40000
    s_mov_b32 s23, 0x00020000
    s_add_u32 s24, s8, s47
    s_addc_u32 s25, s9, 0
    s_and_b32 s25, s25, 0xffff
    s_mov_b32 s26, 0x40000
    s_mov_b32 s27, 0x00020000
    s_mov_b32 s32, s12
    s_and_b32 s33, s13, 0xffff
    s_mov_b32 s34, 0x400000
    s_mov_b32 s35, 0x00020000
    s_mov_b32 s36, s14
    s_and_b32 s37, s15, 0xffff
    s_mov_b32 s38, 0x200000
    s_mov_b32 s39, 0x00020000
    s_lshl_b32 s66, s40, 2
    s_add_u32 s66, s66, 1581056
    s_load_dword s67, s[14:15], s66
    s_load_dwordx2 s[64:65], s[0:1], 80
    s_mul_i32 s55, s40, 4
    s_xor_b32 s55, s55, s3
    s_and_b32 s55, s55, 7
    s_lshl_b32 s55, s55, 12
    s_mov_b32 s56, s55
    s_lshl_b32 s62, s41, 19
    s_add_u32 s62, s62, s54
    s_add_u32 s57, s62, s59
    s_mov_b32 s61, 0x3e0293ee
    v_lshlrev_b32 v5, 12, v13
    v_lshl_add_u32 v5, v12, 10, v5
    v_lshl_add_u32 v5, v14, 4, v5
    v_and_b32 v254, 16, v1
    v_lshl_add_u32 v5, v254, 13, v5
    v_xor_b32 v5, s59, v5
    v_bfe_u32 v14, v1, 2, 2
    v_and_b32 v15, 3, v1
    v_lshlrev_b32 v2, 8, v14
    v_lshl_add_u32 v2, v12, 6, v2
    v_lshl_add_u32 v2, v15, 4, v2
    v_lshlrev_b32 v3, 4, v1
    s_lshl_b32 s56, s40, 3
    s_add_u32 s56, s56, s41
    s_lshl_b32 s56, s56, 3
    s_add_u32 s56, s56, s3
    s_mov_b32 s55, 0
    s_bitcmp1_b32 s56, 0
    s_cselect_b32 s50, 0x15f00, 0
    s_xor_b32 s55, s55, s50
    s_bitcmp1_b32 s56, 1
    s_cselect_b32 s50, 0x29000, 0
    s_xor_b32 s55, s55, s50
    s_bitcmp1_b32 s56, 2
    s_cselect_b32 s50, 0x34b00, 0
    s_xor_b32 s55, s55, s50
    s_bitcmp1_b32 s56, 3
    s_cselect_b32 s50, 0x3f400, 0
    s_xor_b32 s55, s55, s50
    s_bitcmp1_b32 s56, 4
    s_cselect_b32 s50, 0x3ed00, 0
    s_xor_b32 s55, s55, s50
    s_bitcmp1_b32 s56, 5
    s_cselect_b32 s50, 0x3db00, 0
    s_xor_b32 s55, s55, s50
    s_bitcmp1_b32 s56, 6
    s_cselect_b32 s50, 0x35000, 0
    s_xor_b32 s55, s55, s50
    s_bitcmp1_b32 s56, 7
    s_cselect_b32 s50, 0x2ed00, 0
    s_xor_b32 s55, s55, s50
    v_and_b32 v248, 0xff, v2
    v_and_b32 v249, 0xff, v3
    v_xor_b32 v248, s55, v248
    v_xor_b32 v249, s55, v249
    v_bfe_i32 v250, v1, 2, 1
    v_and_b32 v250, 0x20400, v250
    v_xor_b32 v248, v248, v250
    v_bfe_i32 v250, v1, 3, 1
    v_and_b32 v250, 0x22300, v250
    v_xor_b32 v248, v248, v250
    v_bfe_i32 v250, v1, 4, 1
    v_and_b32 v250, 0x20400, v250
    v_xor_b32 v249, v249, v250
    v_bfe_i32 v250, v1, 5, 1
    v_and_b32 v250, 0x22300, v250
    v_xor_b32 v249, v249, v250
    v_lshlrev_b32 v12, 2, v0
    v_mov_b32 v13, 0
    ds_write_b32 v12, v13 offset:16384
    v_and_b32 v12, 12, v12
    v_mov_b32 v14, 0xff800000
    ds_write_b32 v12, v14 offset:18432
    ds_write_b32 v12, v13 offset:18448
    v_and_b32 v12, 3, v1
    v_lshlrev_b32 v12, 4, v12
    v_mov_b32 v14, 0xffff
    v_mov_b32 v15, 0
    v_lshlrev_b64 v[6:7], v12, v[14:15]
    v_mov_b32 v13, 0x0c0c0c0c
    s_mov_b32 s44, 0x01000100
    s_mov_b32 s45, 0x03020302
    v_bfi_b32 v8, v6, s44, v13
    v_bfi_b32 v9, v7, s44, v13
    v_bfi_b32 v10, v6, s45, v13
    v_bfi_b32 v11, v7, s45, v13
    v_mov_b32 v20, 0
    v_mov_b32 v21, 0
    v_mov_b32 v24, 0
    v_mov_b32 v25, 0
    v_mov_b32 v28, 0
    v_mov_b32 v29, 0
    v_mov_b32 v32, 0
    v_mov_b32 v33, 0
    v_mov_b32 v36, 0
    v_mov_b32 v37, 0
    s_waitcnt vmcnt(4)
    s_mov_b32 exec_lo, 0xffff0000
    s_mov_b32 exec_hi, 0xffff0000
    v_swap_b32 v72, v73
    v_swap_b32 v74, v75
    v_swap_b32 v76, v77
    v_swap_b32 v78, v79
    v_swap_b32 v80, v81
    v_swap_b32 v82, v83
    v_swap_b32 v84, v85
    v_swap_b32 v86, v87
    v_swap_b32 v88, v89
    v_swap_b32 v90, v91
    v_swap_b32 v92, v93
    v_swap_b32 v94, v95
    v_swap_b32 v96, v97
    v_swap_b32 v98, v99
    v_swap_b32 v100, v101
    v_swap_b32 v102, v103
    s_mov_b64 exec, -1
    v_perm_b32 v22, v72, v72, v8
    v_perm_b32 v23, v72, v72, v9
    s_nop 1
    v_mfma_f32_16x16x32_bf16 v[56:59], v[22:25], v[136:139], 0
    v_mfma_f32_16x16x32_bf16 v[60:63], v[20:23], v[136:139], 0
    v_perm_b32 v26, v72, v72, v10
    v_perm_b32 v27, v72, v72, v11
    s_nop 1
    v_mfma_f32_16x16x32_bf16 v[56:59], v[26:29], v[140:143], v[56:59]
    v_mfma_f32_16x16x32_bf16 v[60:63], v[24:27], v[140:143], v[60:63]
    v_xor_b32 v252, 0x10000, v4
    buffer_load_dwordx4 v[168:171], v252, s[28:31], s58 offen
    v_perm_b32 v30, v73, v73, v8
    v_perm_b32 v31, v73, v73, v9
    s_nop 1
    v_mfma_f32_16x16x32_bf16 v[56:59], v[30:33], v[144:147], v[56:59]
    v_mfma_f32_16x16x32_bf16 v[60:63], v[28:31], v[144:147], v[60:63]
    v_xor_b32 v253, 0x12000, v4
    buffer_load_dwordx4 v[172:175], v253, s[28:31], s58 offen
    v_perm_b32 v34, v73, v73, v10
    v_perm_b32 v35, v73, v73, v11
    s_nop 1
    v_mfma_f32_16x16x32_bf16 v[56:59], v[34:37], v[148:151], v[56:59]
    v_mfma_f32_16x16x32_bf16 v[60:63], v[32:35], v[148:151], v[60:63]
    v_xor_b32 v252, 0x14000, v4
    buffer_load_dwordx4 v[176:179], v252, s[28:31], s58 offen
    s_waitcnt vmcnt(6)
    v_perm_b32 v22, v74, v74, v8
    v_perm_b32 v23, v74, v74, v9
    s_nop 1
    v_mfma_f32_16x16x32_bf16 v[56:59], v[22:25], v[152:155], v[56:59]
    v_mfma_f32_16x16x32_bf16 v[60:63], v[20:23], v[152:155], v[60:63]
    v_xor_b32 v253, 0x16000, v4
    buffer_load_dwordx4 v[180:183], v253, s[28:31], s58 offen
    s_waitcnt vmcnt(6)
    v_perm_b32 v26, v74, v74, v10
    v_perm_b32 v27, v74, v74, v11
    s_nop 1
    v_mfma_f32_16x16x32_bf16 v[56:59], v[26:29], v[156:159], v[56:59]
    v_mfma_f32_16x16x32_bf16 v[60:63], v[24:27], v[156:159], v[60:63]
    v_xor_b32 v252, 0x18000, v4
    buffer_load_dwordx4 v[184:187], v252, s[28:31], s58 offen
    s_waitcnt vmcnt(6)
    v_perm_b32 v30, v75, v75, v8
    v_perm_b32 v31, v75, v75, v9
    s_nop 1
    v_mfma_f32_16x16x32_bf16 v[56:59], v[30:33], v[160:163], v[56:59]
    v_mfma_f32_16x16x32_bf16 v[60:63], v[28:31], v[160:163], v[60:63]
    v_xor_b32 v253, 0x1a000, v4
    buffer_load_dwordx4 v[188:191], v253, s[28:31], s58 offen
    s_waitcnt vmcnt(6)
    v_perm_b32 v34, v75, v75, v10
    v_perm_b32 v35, v75, v75, v11
    s_nop 1
    v_mfma_f32_16x16x32_bf16 v[56:59], v[34:37], v[164:167], v[56:59]
    v_mfma_f32_16x16x32_bf16 v[60:63], v[32:35], v[164:167], v[60:63]
    v_xor_b32 v252, 0x1c000, v4
    buffer_load_dwordx4 v[192:195], v252, s[28:31], s58 offen
    s_waitcnt vmcnt(6)
    v_perm_b32 v22, v76, v76, v8
    v_perm_b32 v23, v76, v76, v9
    s_nop 1
    v_mfma_f32_16x16x32_bf16 v[56:59], v[22:25], v[168:171], v[56:59]
    v_mfma_f32_16x16x32_bf16 v[60:63], v[20:23], v[168:171], v[60:63]
    v_xor_b32 v253, 0x1e000, v4
    buffer_load_dwordx4 v[196:199], v253, s[28:31], s58 offen
    s_waitcnt vmcnt(6)
    v_perm_b32 v26, v76, v76, v10
    v_perm_b32 v27, v76, v76, v11
    s_nop 1
    v_mfma_f32_16x16x32_bf16 v[56:59], v[26:29], v[172:175], v[56:59]
    v_mfma_f32_16x16x32_bf16 v[60:63], v[24:27], v[172:175], v[60:63]
    v_xor_b32 v252, 0x20000, v4
    buffer_load_dwordx4 v[200:203], v252, s[28:31], s58 offen
    s_waitcnt vmcnt(6)
    v_perm_b32 v30, v77, v77, v8
    v_perm_b32 v31, v77, v77, v9
    s_nop 1
    v_mfma_f32_16x16x32_bf16 v[56:59], v[30:33], v[176:179], v[56:59]
    v_mfma_f32_16x16x32_bf16 v[60:63], v[28:31], v[176:179], v[60:63]
    v_xor_b32 v253, 0x22000, v4
    buffer_load_dwordx4 v[204:207], v253, s[28:31], s58 offen
    s_waitcnt vmcnt(6)
    v_perm_b32 v34, v77, v77, v10
    v_perm_b32 v35, v77, v77, v11
    s_nop 1
    v_mfma_f32_16x16x32_bf16 v[56:59], v[34:37], v[180:183], v[56:59]
    v_mfma_f32_16x16x32_bf16 v[60:63], v[32:35], v[180:183], v[60:63]
    v_xor_b32 v252, 0x24000, v4
    buffer_load_dwordx4 v[208:211], v252, s[28:31], s58 offen
    s_waitcnt vmcnt(6)
    v_perm_b32 v22, v78, v78, v8
    v_perm_b32 v23, v78, v78, v9
    s_nop 1
    v_mfma_f32_16x16x32_bf16 v[56:59], v[22:25], v[184:187], v[56:59]
    v_mfma_f32_16x16x32_bf16 v[60:63], v[20:23], v[184:187], v[60:63]
    v_xor_b32 v253, 0x26000, v4
    buffer_load_dwordx4 v[212:215], v253, s[28:31], s58 offen
    s_waitcnt vmcnt(6)
    v_perm_b32 v26, v78, v78, v10
    v_perm_b32 v27, v78, v78, v11
    s_nop 1
    v_mfma_f32_16x16x32_bf16 v[56:59], v[26:29], v[188:191], v[56:59]
    v_mfma_f32_16x16x32_bf16 v[60:63], v[24:27], v[188:191], v[60:63]
    v_xor_b32 v252, 0x28000, v4
    buffer_load_dwordx4 v[216:219], v252, s[28:31], s58 offen
    s_waitcnt vmcnt(6)
    v_perm_b32 v30, v79, v79, v8
    v_perm_b32 v31, v79, v79, v9
    s_nop 1
    v_mfma_f32_16x16x32_bf16 v[56:59], v[30:33], v[192:195], v[56:59]
    v_mfma_f32_16x16x32_bf16 v[60:63], v[28:31], v[192:195], v[60:63]
    v_xor_b32 v253, 0x2a000, v4
    buffer_load_dwordx4 v[220:223], v253, s[28:31], s58 offen
    s_waitcnt vmcnt(6)
    v_perm_b32 v34, v79, v79, v10
    v_perm_b32 v35, v79, v79, v11
    s_nop 1
    v_mfma_f32_16x16x32_bf16 v[56:59], v[34:37], v[196:199], v[56:59]
    v_mfma_f32_16x16x32_bf16 v[60:63], v[32:35], v[196:199], v[60:63]
    v_xor_b32 v252, 0x2c000, v4
    buffer_load_dwordx4 v[224:227], v252, s[28:31], s58 offen
    s_waitcnt vmcnt(6)
    v_perm_b32 v22, v80, v80, v8
    v_perm_b32 v23, v80, v80, v9
    s_nop 1
    v_mfma_f32_16x16x32_bf16 v[56:59], v[22:25], v[200:203], v[56:59]
    v_mfma_f32_16x16x32_bf16 v[60:63], v[20:23], v[200:203], v[60:63]
    v_xor_b32 v253, 0x2e000, v4
    buffer_load_dwordx4 v[228:231], v253, s[28:31], s58 offen
    s_waitcnt vmcnt(6)
    v_perm_b32 v26, v80, v80, v10
    v_perm_b32 v27, v80, v80, v11
    s_nop 1
    v_mfma_f32_16x16x32_bf16 v[56:59], v[26:29], v[204:207], v[56:59]
    v_mfma_f32_16x16x32_bf16 v[60:63], v[24:27], v[204:207], v[60:63]
    v_xor_b32 v252, 0x30000, v4
    buffer_load_dwordx4 v[232:235], v252, s[28:31], s58 offen
    s_waitcnt vmcnt(6)
    v_perm_b32 v30, v81, v81, v8
    v_perm_b32 v31, v81, v81, v9
    s_nop 1
    v_mfma_f32_16x16x32_bf16 v[56:59], v[30:33], v[208:211], v[56:59]
    v_mfma_f32_16x16x32_bf16 v[60:63], v[28:31], v[208:211], v[60:63]
    v_xor_b32 v253, 0x32000, v4
    buffer_load_dwordx4 v[236:239], v253, s[28:31], s58 offen
    s_waitcnt vmcnt(6)
    v_perm_b32 v34, v81, v81, v10
    v_perm_b32 v35, v81, v81, v11
    s_nop 1
    v_mfma_f32_16x16x32_bf16 v[56:59], v[34:37], v[212:215], v[56:59]
    v_mfma_f32_16x16x32_bf16 v[60:63], v[32:35], v[212:215], v[60:63]
    v_xor_b32 v252, 0x34000, v4
    buffer_load_dwordx4 v[240:243], v252, s[28:31], s58 offen
    s_waitcnt vmcnt(6)
    v_perm_b32 v22, v82, v82, v8
    v_perm_b32 v23, v82, v82, v9
    s_nop 1
    v_mfma_f32_16x16x32_bf16 v[56:59], v[22:25], v[216:219], v[56:59]
    v_mfma_f32_16x16x32_bf16 v[60:63], v[20:23], v[216:219], v[60:63]
    v_xor_b32 v253, 0x36000, v4
    buffer_load_dwordx4 v[244:247], v253, s[28:31], s58 offen
    s_waitcnt vmcnt(6)
    v_perm_b32 v26, v82, v82, v10
    v_perm_b32 v27, v82, v82, v11
    s_nop 1
    v_mfma_f32_16x16x32_bf16 v[56:59], v[26:29], v[220:223], v[56:59]
    v_mfma_f32_16x16x32_bf16 v[60:63], v[24:27], v[220:223], v[60:63]
    v_xor_b32 v252, 0x38000, v4
    buffer_load_dwordx4 v[136:139], v252, s[28:31], s58 offen
    s_waitcnt vmcnt(6)
    v_perm_b32 v30, v83, v83, v8
    v_perm_b32 v31, v83, v83, v9
    s_nop 1
    v_mfma_f32_16x16x32_bf16 v[56:59], v[30:33], v[224:227], v[56:59]
    v_mfma_f32_16x16x32_bf16 v[60:63], v[28:31], v[224:227], v[60:63]
    v_xor_b32 v253, 0x3a000, v4
    buffer_load_dwordx4 v[140:143], v253, s[28:31], s58 offen
    s_waitcnt vmcnt(6)
    v_perm_b32 v34, v83, v83, v10
    v_perm_b32 v35, v83, v83, v11
    s_nop 1
    v_mfma_f32_16x16x32_bf16 v[56:59], v[34:37], v[228:231], v[56:59]
    v_mfma_f32_16x16x32_bf16 v[60:63], v[32:35], v[228:231], v[60:63]
    v_xor_b32 v252, 0x3c000, v4
    buffer_load_dwordx4 v[144:147], v252, s[28:31], s58 offen
    s_waitcnt vmcnt(6)
    v_perm_b32 v22, v84, v84, v8
    v_perm_b32 v23, v84, v84, v9
    s_nop 1
    v_mfma_f32_16x16x32_bf16 v[56:59], v[22:25], v[232:235], v[56:59]
    v_mfma_f32_16x16x32_bf16 v[60:63], v[20:23], v[232:235], v[60:63]
    v_xor_b32 v253, 0x3e000, v4
    buffer_load_dwordx4 v[148:151], v253, s[28:31], s58 offen
    s_waitcnt vmcnt(6)
    v_perm_b32 v26, v84, v84, v10
    v_perm_b32 v27, v84, v84, v11
    s_nop 1
    v_mfma_f32_16x16x32_bf16 v[56:59], v[26:29], v[236:239], v[56:59]
    v_mfma_f32_16x16x32_bf16 v[60:63], v[24:27], v[236:239], v[60:63]
    v_xor_b32 v252, 0x40000, v4
    buffer_load_dwordx4 v[152:155], v252, s[28:31], s58 offen
    s_waitcnt vmcnt(6)
    v_perm_b32 v30, v85, v85, v8
    v_perm_b32 v31, v85, v85, v9
    s_nop 1
    v_mfma_f32_16x16x32_bf16 v[56:59], v[30:33], v[240:243], v[56:59]
    v_mfma_f32_16x16x32_bf16 v[60:63], v[28:31], v[240:243], v[60:63]
    v_xor_b32 v253, 0x42000, v4
    buffer_load_dwordx4 v[156:159], v253, s[28:31], s58 offen
    s_waitcnt vmcnt(6)
    v_perm_b32 v34, v85, v85, v10
    v_perm_b32 v35, v85, v85, v11
    s_nop 1
    v_mfma_f32_16x16x32_bf16 v[56:59], v[34:37], v[244:247], v[56:59]
    v_mfma_f32_16x16x32_bf16 v[60:63], v[32:35], v[244:247], v[60:63]
    v_xor_b32 v252, 0x44000, v4
    buffer_load_dwordx4 v[160:163], v252, s[28:31], s58 offen
    s_waitcnt vmcnt(6)
    v_perm_b32 v22, v86, v86, v8
    v_perm_b32 v23, v86, v86, v9
    s_nop 1
    v_mfma_f32_16x16x32_bf16 v[56:59], v[22:25], v[136:139], v[56:59]
    v_mfma_f32_16x16x32_bf16 v[60:63], v[20:23], v[136:139], v[60:63]
    v_xor_b32 v253, 0x46000, v4
    buffer_load_dwordx4 v[164:167], v253, s[28:31], s58 offen
    s_waitcnt vmcnt(6)
    v_perm_b32 v26, v86, v86, v10
    v_perm_b32 v27, v86, v86, v11
    s_nop 1
    v_mfma_f32_16x16x32_bf16 v[56:59], v[26:29], v[140:143], v[56:59]
    v_mfma_f32_16x16x32_bf16 v[60:63], v[24:27], v[140:143], v[60:63]
    v_xor_b32 v252, 0x48000, v4
    buffer_load_dwordx4 v[168:171], v252, s[28:31], s58 offen
    s_waitcnt vmcnt(6)
    v_perm_b32 v30, v87, v87, v8
    v_perm_b32 v31, v87, v87, v9
    s_nop 1
    v_mfma_f32_16x16x32_bf16 v[56:59], v[30:33], v[144:147], v[56:59]
    v_mfma_f32_16x16x32_bf16 v[60:63], v[28:31], v[144:147], v[60:63]
    v_xor_b32 v253, 0x4a000, v4
    buffer_load_dwordx4 v[172:175], v253, s[28:31], s58 offen
    s_waitcnt vmcnt(6)
    v_perm_b32 v34, v87, v87, v10
    v_perm_b32 v35, v87, v87, v11
    s_nop 1
    v_mfma_f32_16x16x32_bf16 v[56:59], v[34:37], v[148:151], v[56:59]
    v_mfma_f32_16x16x32_bf16 v[60:63], v[32:35], v[148:151], v[60:63]
    v_xor_b32 v252, 0x4c000, v4
    buffer_load_dwordx4 v[176:179], v252, s[28:31], s58 offen
    s_waitcnt vmcnt(6)
    v_perm_b32 v22, v88, v88, v8
    v_perm_b32 v23, v88, v88, v9
    s_nop 1
    v_mfma_f32_16x16x32_bf16 v[56:59], v[22:25], v[152:155], v[56:59]
    v_mfma_f32_16x16x32_bf16 v[60:63], v[20:23], v[152:155], v[60:63]
    v_xor_b32 v253, 0x4e000, v4
    buffer_load_dwordx4 v[180:183], v253, s[28:31], s58 offen
    s_waitcnt vmcnt(6)
    v_perm_b32 v26, v88, v88, v10
    v_perm_b32 v27, v88, v88, v11
    s_nop 1
    v_mfma_f32_16x16x32_bf16 v[56:59], v[26:29], v[156:159], v[56:59]
    v_mfma_f32_16x16x32_bf16 v[60:63], v[24:27], v[156:159], v[60:63]
    v_xor_b32 v252, 0x50000, v4
    buffer_load_dwordx4 v[184:187], v252, s[28:31], s58 offen
    s_waitcnt vmcnt(6)
    v_perm_b32 v30, v89, v89, v8
    v_perm_b32 v31, v89, v89, v9
    s_nop 1
    v_mfma_f32_16x16x32_bf16 v[56:59], v[30:33], v[160:163], v[56:59]
    v_mfma_f32_16x16x32_bf16 v[60:63], v[28:31], v[160:163], v[60:63]
    v_xor_b32 v253, 0x52000, v4
    buffer_load_dwordx4 v[188:191], v253, s[28:31], s58 offen
    s_waitcnt vmcnt(6)
    v_perm_b32 v34, v89, v89, v10
    v_perm_b32 v35, v89, v89, v11
    s_nop 1
    v_mfma_f32_16x16x32_bf16 v[56:59], v[34:37], v[164:167], v[56:59]
    v_mfma_f32_16x16x32_bf16 v[60:63], v[32:35], v[164:167], v[60:63]
    v_xor_b32 v252, 0x54000, v4
    buffer_load_dwordx4 v[192:195], v252, s[28:31], s58 offen
    s_waitcnt vmcnt(6)
    v_perm_b32 v22, v90, v90, v8
    v_perm_b32 v23, v90, v90, v9
    s_nop 1
    v_mfma_f32_16x16x32_bf16 v[56:59], v[22:25], v[168:171], v[56:59]
    v_mfma_f32_16x16x32_bf16 v[60:63], v[20:23], v[168:171], v[60:63]
    v_xor_b32 v253, 0x56000, v4
    buffer_load_dwordx4 v[196:199], v253, s[28:31], s58 offen
    s_waitcnt vmcnt(6)
    v_perm_b32 v26, v90, v90, v10
    v_perm_b32 v27, v90, v90, v11
    s_nop 1
    v_mfma_f32_16x16x32_bf16 v[56:59], v[26:29], v[172:175], v[56:59]
    v_mfma_f32_16x16x32_bf16 v[60:63], v[24:27], v[172:175], v[60:63]
    v_xor_b32 v252, 0x58000, v4
    buffer_load_dwordx4 v[200:203], v252, s[28:31], s58 offen
    s_waitcnt vmcnt(6)
    v_perm_b32 v30, v91, v91, v8
    v_perm_b32 v31, v91, v91, v9
    s_nop 1
    v_mfma_f32_16x16x32_bf16 v[56:59], v[30:33], v[176:179], v[56:59]
    v_mfma_f32_16x16x32_bf16 v[60:63], v[28:31], v[176:179], v[60:63]
    v_xor_b32 v253, 0x5a000, v4
    buffer_load_dwordx4 v[204:207], v253, s[28:31], s58 offen
    s_waitcnt vmcnt(6)
    v_perm_b32 v34, v91, v91, v10
    v_perm_b32 v35, v91, v91, v11
    s_nop 1
    v_mfma_f32_16x16x32_bf16 v[56:59], v[34:37], v[180:183], v[56:59]
    v_mfma_f32_16x16x32_bf16 v[60:63], v[32:35], v[180:183], v[60:63]
    v_xor_b32 v252, 0x5c000, v4
    buffer_load_dwordx4 v[208:211], v252, s[28:31], s58 offen
    s_waitcnt vmcnt(6)
    v_perm_b32 v22, v92, v92, v8
    v_perm_b32 v23, v92, v92, v9
    s_nop 1
    v_mfma_f32_16x16x32_bf16 v[56:59], v[22:25], v[184:187], v[56:59]
    v_mfma_f32_16x16x32_bf16 v[60:63], v[20:23], v[184:187], v[60:63]
    v_xor_b32 v253, 0x5e000, v4
    buffer_load_dwordx4 v[212:215], v253, s[28:31], s58 offen
    s_waitcnt vmcnt(6)
    v_perm_b32 v26, v92, v92, v10
    v_perm_b32 v27, v92, v92, v11
    s_nop 1
    v_mfma_f32_16x16x32_bf16 v[56:59], v[26:29], v[188:191], v[56:59]
    v_mfma_f32_16x16x32_bf16 v[60:63], v[24:27], v[188:191], v[60:63]
    v_xor_b32 v252, 0x60000, v4
    buffer_load_dwordx4 v[216:219], v252, s[28:31], s58 offen
    s_waitcnt vmcnt(6)
    v_perm_b32 v30, v93, v93, v8
    v_perm_b32 v31, v93, v93, v9
    s_nop 1
    v_mfma_f32_16x16x32_bf16 v[56:59], v[30:33], v[192:195], v[56:59]
    v_mfma_f32_16x16x32_bf16 v[60:63], v[28:31], v[192:195], v[60:63]
    v_xor_b32 v253, 0x62000, v4
    buffer_load_dwordx4 v[220:223], v253, s[28:31], s58 offen
    s_waitcnt vmcnt(6)
    v_perm_b32 v34, v93, v93, v10
    v_perm_b32 v35, v93, v93, v11
    s_nop 1
    v_mfma_f32_16x16x32_bf16 v[56:59], v[34:37], v[196:199], v[56:59]
    v_mfma_f32_16x16x32_bf16 v[60:63], v[32:35], v[196:199], v[60:63]
    v_xor_b32 v252, 0x64000, v4
    buffer_load_dwordx4 v[224:227], v252, s[28:31], s58 offen
    s_waitcnt vmcnt(6)
    v_perm_b32 v22, v94, v94, v8
    v_perm_b32 v23, v94, v94, v9
    s_nop 1
    v_mfma_f32_16x16x32_bf16 v[56:59], v[22:25], v[200:203], v[56:59]
    v_mfma_f32_16x16x32_bf16 v[60:63], v[20:23], v[200:203], v[60:63]
    v_xor_b32 v253, 0x66000, v4
    buffer_load_dwordx4 v[228:231], v253, s[28:31], s58 offen
    s_waitcnt vmcnt(6)
    v_perm_b32 v26, v94, v94, v10
    v_perm_b32 v27, v94, v94, v11
    s_nop 1
    v_mfma_f32_16x16x32_bf16 v[56:59], v[26:29], v[204:207], v[56:59]
    v_mfma_f32_16x16x32_bf16 v[60:63], v[24:27], v[204:207], v[60:63]
    v_xor_b32 v252, 0x68000, v4
    buffer_load_dwordx4 v[232:235], v252, s[28:31], s58 offen
    s_waitcnt vmcnt(6)
    v_perm_b32 v30, v95, v95, v8
    v_perm_b32 v31, v95, v95, v9
    s_nop 1
    v_mfma_f32_16x16x32_bf16 v[56:59], v[30:33], v[208:211], v[56:59]
    v_mfma_f32_16x16x32_bf16 v[60:63], v[28:31], v[208:211], v[60:63]
    v_xor_b32 v253, 0x6a000, v4
    buffer_load_dwordx4 v[236:239], v253, s[28:31], s58 offen
    s_waitcnt vmcnt(6)
    v_perm_b32 v34, v95, v95, v10
    v_perm_b32 v35, v95, v95, v11
    s_nop 1
    v_mfma_f32_16x16x32_bf16 v[56:59], v[34:37], v[212:215], v[56:59]
    v_mfma_f32_16x16x32_bf16 v[60:63], v[32:35], v[212:215], v[60:63]
    v_xor_b32 v252, 0x6c000, v4
    buffer_load_dwordx4 v[240:243], v252, s[28:31], s58 offen
    s_waitcnt vmcnt(6)
    v_perm_b32 v22, v96, v96, v8
    v_perm_b32 v23, v96, v96, v9
    s_nop 1
    v_mfma_f32_16x16x32_bf16 v[56:59], v[22:25], v[216:219], v[56:59]
    v_mfma_f32_16x16x32_bf16 v[60:63], v[20:23], v[216:219], v[60:63]
    v_xor_b32 v253, 0x6e000, v4
    buffer_load_dwordx4 v[244:247], v253, s[28:31], s58 offen
    s_waitcnt vmcnt(6)
    v_perm_b32 v26, v96, v96, v10
    v_perm_b32 v27, v96, v96, v11
    s_nop 1
    v_mfma_f32_16x16x32_bf16 v[56:59], v[26:29], v[220:223], v[56:59]
    v_mfma_f32_16x16x32_bf16 v[60:63], v[24:27], v[220:223], v[60:63]
    v_xor_b32 v252, 0x70000, v4
    buffer_load_dwordx4 v[136:139], v252, s[28:31], s58 offen
    s_waitcnt vmcnt(6)
    v_perm_b32 v30, v97, v97, v8
    v_perm_b32 v31, v97, v97, v9
    s_nop 1
    v_mfma_f32_16x16x32_bf16 v[56:59], v[30:33], v[224:227], v[56:59]
    v_mfma_f32_16x16x32_bf16 v[60:63], v[28:31], v[224:227], v[60:63]
    v_xor_b32 v253, 0x72000, v4
    buffer_load_dwordx4 v[140:143], v253, s[28:31], s58 offen
    s_waitcnt vmcnt(6)
    v_perm_b32 v34, v97, v97, v10
    v_perm_b32 v35, v97, v97, v11
    s_nop 1
    v_mfma_f32_16x16x32_bf16 v[56:59], v[34:37], v[228:231], v[56:59]
    v_mfma_f32_16x16x32_bf16 v[60:63], v[32:35], v[228:231], v[60:63]
    v_xor_b32 v252, 0x74000, v4
    buffer_load_dwordx4 v[144:147], v252, s[28:31], s58 offen
    s_waitcnt vmcnt(6)
    v_perm_b32 v22, v98, v98, v8
    v_perm_b32 v23, v98, v98, v9
    s_nop 1
    v_mfma_f32_16x16x32_bf16 v[56:59], v[22:25], v[232:235], v[56:59]
    v_mfma_f32_16x16x32_bf16 v[60:63], v[20:23], v[232:235], v[60:63]
    v_xor_b32 v253, 0x76000, v4
    buffer_load_dwordx4 v[148:151], v253, s[28:31], s58 offen
    s_waitcnt vmcnt(6)
    v_perm_b32 v26, v98, v98, v10
    v_perm_b32 v27, v98, v98, v11
    s_nop 1
    v_mfma_f32_16x16x32_bf16 v[56:59], v[26:29], v[236:239], v[56:59]
    v_mfma_f32_16x16x32_bf16 v[60:63], v[24:27], v[236:239], v[60:63]
    v_xor_b32 v252, 0x78000, v4
    buffer_load_dwordx4 v[152:155], v252, s[28:31], s58 offen
    s_waitcnt vmcnt(6)
    v_perm_b32 v30, v99, v99, v8
    v_perm_b32 v31, v99, v99, v9
    s_nop 1
    v_mfma_f32_16x16x32_bf16 v[56:59], v[30:33], v[240:243], v[56:59]
    v_mfma_f32_16x16x32_bf16 v[60:63], v[28:31], v[240:243], v[60:63]
    v_xor_b32 v253, 0x7a000, v4
    buffer_load_dwordx4 v[156:159], v253, s[28:31], s58 offen
    s_waitcnt vmcnt(6)
    v_perm_b32 v34, v99, v99, v10
    v_perm_b32 v35, v99, v99, v11
    s_nop 1
    v_mfma_f32_16x16x32_bf16 v[56:59], v[34:37], v[244:247], v[56:59]
    v_mfma_f32_16x16x32_bf16 v[60:63], v[32:35], v[244:247], v[60:63]
    v_xor_b32 v252, 0x7c000, v4
    buffer_load_dwordx4 v[160:163], v252, s[28:31], s58 offen
    s_waitcnt vmcnt(6)
    v_perm_b32 v22, v100, v100, v8
    v_perm_b32 v23, v100, v100, v9
    s_nop 1
    v_mfma_f32_16x16x32_bf16 v[56:59], v[22:25], v[136:139], v[56:59]
    v_mfma_f32_16x16x32_bf16 v[60:63], v[20:23], v[136:139], v[60:63]
    v_xor_b32 v253, 0x7e000, v4
    buffer_load_dwordx4 v[164:167], v253, s[28:31], s58 offen
    s_waitcnt vmcnt(6)
    v_perm_b32 v26, v100, v100, v10
    v_perm_b32 v27, v100, v100, v11
    s_nop 1
    v_mfma_f32_16x16x32_bf16 v[56:59], v[26:29], v[140:143], v[56:59]
    v_mfma_f32_16x16x32_bf16 v[60:63], v[24:27], v[140:143], v[60:63]
    buffer_load_dwordx4 v[168:171], v248, s[20:23], 0 offen nt
    s_waitcnt vmcnt(6)
    v_perm_b32 v30, v101, v101, v8
    v_perm_b32 v31, v101, v101, v9
    s_nop 1
    v_mfma_f32_16x16x32_bf16 v[56:59], v[30:33], v[144:147], v[56:59]
    v_mfma_f32_16x16x32_bf16 v[60:63], v[28:31], v[144:147], v[60:63]
    v_xor_b32 v251, 0x15900, v248
    buffer_load_dwordx4 v[172:175], v251, s[20:23], 0 offen nt
    s_waitcnt vmcnt(6)
    v_perm_b32 v34, v101, v101, v10
    v_perm_b32 v35, v101, v101, v11
    s_nop 1
    v_mfma_f32_16x16x32_bf16 v[56:59], v[34:37], v[148:151], v[56:59]
    v_mfma_f32_16x16x32_bf16 v[60:63], v[32:35], v[148:151], v[60:63]
    v_xor_b32 v250, 0x5000, v248
    buffer_load_dwordx4 v[176:179], v250, s[20:23], 0 offen nt
    s_waitcnt vmcnt(6)
    v_perm_b32 v22, v102, v102, v8
    v_perm_b32 v23, v102, v102, v9
    s_nop 1
    v_mfma_f32_16x16x32_bf16 v[56:59], v[22:25], v[152:155], v[56:59]
    v_mfma_f32_16x16x32_bf16 v[60:63], v[20:23], v[152:155], v[60:63]
    v_xor_b32 v251, 0x10900, v248
    buffer_load_dwordx4 v[180:183], v251, s[20:23], 0 offen nt
    s_waitcnt vmcnt(6)
    v_perm_b32 v26, v102, v102, v10
    v_perm_b32 v27, v102, v102, v11
    s_nop 1
    v_mfma_f32_16x16x32_bf16 v[56:59], v[26:29], v[156:159], v[56:59]
    v_mfma_f32_16x16x32_bf16 v[60:63], v[24:27], v[156:159], v[60:63]
    v_xor_b32 v250, 0x31000, v248
    buffer_load_dwordx4 v[184:187], v250, s[20:23], 0 offen nt
    s_waitcnt vmcnt(6)
    v_perm_b32 v30, v103, v103, v8
    v_perm_b32 v31, v103, v103, v9
    s_nop 1
    v_mfma_f32_16x16x32_bf16 v[56:59], v[30:33], v[160:163], v[56:59]
    v_mfma_f32_16x16x32_bf16 v[60:63], v[28:31], v[160:163], v[60:63]
    v_xor_b32 v251, 0x24900, v248
    buffer_load_dwordx4 v[188:191], v251, s[20:23], 0 offen nt
    s_waitcnt vmcnt(6)
    v_perm_b32 v34, v103, v103, v10
    v_perm_b32 v35, v103, v103, v11
    s_nop 1
    v_mfma_f32_16x16x32_bf16 v[56:59], v[34:37], v[164:167], v[56:59]
    v_mfma_f32_16x16x32_bf16 v[60:63], v[32:35], v[164:167], v[60:63]
    v_xor_b32 v250, 0x34000, v248
    buffer_load_dwordx4 v[192:195], v250, s[20:23], 0 offen nt
    v_xor_b32 v251, 0x21900, v248
    buffer_load_dwordx4 v[196:199], v251, s[20:23], 0 offen nt
    v_xor_b32 v250, 0x21c00, v248
    buffer_load_dwordx4 v[200:203], v250, s[20:23], 0 offen nt
    v_xor_b32 v251, 0x34500, v248
    buffer_load_dwordx4 v[204:207], v251, s[20:23], 0 offen nt
    v_xor_b32 v250, 0x24c00, v248
    buffer_load_dwordx4 v[208:211], v250, s[20:23], 0 offen nt
    v_xor_b32 v251, 0x31500, v248
    buffer_load_dwordx4 v[212:215], v251, s[20:23], 0 offen nt
    v_xor_b32 v250, 0x10c00, v248
    buffer_load_dwordx4 v[216:219], v250, s[20:23], 0 offen nt
    v_xor_b32 v251, 0x5500, v248
    buffer_load_dwordx4 v[220:223], v251, s[20:23], 0 offen nt
    v_xor_b32 v250, 0x15c00, v248
    buffer_load_dwordx4 v[224:227], v250, s[20:23], 0 offen nt
    v_xor_b32 v251, 0x500, v248
    buffer_load_dwordx4 v[228:231], v251, s[20:23], 0 offen nt
    v_xor_b32 v250, 0x24600, v248
    buffer_load_dwordx4 v[232:235], v250, s[20:23], 0 offen nt
    v_xor_b32 v251, 0x31f00, v248
    buffer_load_dwordx4 v[236:239], v251, s[20:23], 0 offen nt
    v_xor_b32 v250, 0x21600, v248
    buffer_load_dwordx4 v[240:243], v250, s[20:23], 0 offen nt
    v_xor_b32 v251, 0x34f00, v248
    buffer_load_dwordx4 v[244:247], v251, s[20:23], 0 offen nt
    v_xor_b32 v250, 0x15600, v248
    buffer_load_dwordx4 v[136:139], v250, s[20:23], 0 offen nt
    v_xor_b32 v251, 0xf00, v248
    buffer_load_dwordx4 v[140:143], v251, s[20:23], 0 offen nt
    v_xor_b32 v250, 0x10600, v248
    buffer_load_dwordx4 v[144:147], v250, s[20:23], 0 offen nt
    v_xor_b32 v251, 0x5f00, v248
    buffer_load_dwordx4 v[148:151], v251, s[20:23], 0 offen nt
    v_xor_b32 v250, 0x5a00, v248
    buffer_load_dwordx4 v[152:155], v250, s[20:23], 0 offen nt
    v_xor_b32 v251, 0x10300, v248
    buffer_load_dwordx4 v[156:159], v251, s[20:23], 0 offen nt
    v_xor_b32 v250, 0xa00, v248
    buffer_load_dwordx4 v[160:163], v250, s[20:23], 0 offen nt
    v_xor_b32 v251, 0x15300, v248
    buffer_load_dwordx4 v[164:167], v251, s[20:23], 0 offen nt
    v_permlane32_swap_b32 v56, v60
    v_permlane32_swap_b32 v57, v61
    v_permlane32_swap_b32 v58, v62
    v_permlane32_swap_b32 v59, v63
    v_add_f32_dpp v56, v60, v56 row_ror:8 row_mask:0xf bank_mask:0xf
    v_add_f32_dpp v57, v61, v57 row_ror:8 row_mask:0xf bank_mask:0xf
    v_add_f32_dpp v58, v62, v58 row_ror:8 row_mask:0xf bank_mask:0xf
    v_add_f32_dpp v59, v63, v59 row_ror:8 row_mask:0xf bank_mask:0xf
    v_cvt_pk_bf16_f32 v56, v56, v57
    v_cvt_pk_bf16_f32 v57, v58, v59
    v_and_b32 v12, 7, v1
    v_lshlrev_b32 v12, 4, v12
    v_lshrrev_b32 v13, 5, v1
    v_lshl_add_u32 v12, v13, 3, v12
    v_and_b32 v13, 8, v1
    v_lshl_add_u32 v12, v13, 7, v12
    v_add_u32 v12, s54, v12
    ds_write_b64 v12, v[56:57] offset:0
    s_waitcnt lgkmcnt(0)
    s_barrier
    ds_read_b128 v[40:43], v2 offset:0
    s_waitcnt lgkmcnt(0)
    s_waitcnt vmcnt(27)
    v_mfma_f32_16x16x32_bf16 v[64:67], v[168:171], v[40:43], 0
    s_waitcnt vmcnt(26)
    v_mfma_f32_16x16x32_bf16 v[68:71], v[172:175], v[40:43], 0
    s_nop 5
    v_mov_b32_dpp v104, v64 quad_perm:[0,0,0,0] row_mask:0xf bank_mask:0xf
    v_mov_b32_dpp v19, v66 quad_perm:[2,2,2,2] row_mask:0xf bank_mask:0xf
    s_nop 0
    v_add_f32_dpp v104, v65, v104 quad_perm:[1,1,1,1] row_mask:0xf bank_mask:0xf
    v_add_f32_dpp v19, v67, v19 quad_perm:[3,3,3,3] row_mask:0xf bank_mask:0xf
    v_add_f32 v104, v104, v19
    s_waitcnt vmcnt(25)
    v_mfma_f32_16x16x32_bf16 v[64:67], v[176:179], v[40:43], 0
    v_mov_b32_dpp v105, v68 quad_perm:[0,0,0,0] row_mask:0xf bank_mask:0xf
    v_mov_b32_dpp v19, v70 quad_perm:[2,2,2,2] row_mask:0xf bank_mask:0xf
    s_nop 0
    v_add_f32_dpp v105, v69, v105 quad_perm:[1,1,1,1] row_mask:0xf bank_mask:0xf
    v_add_f32_dpp v19, v71, v19 quad_perm:[3,3,3,3] row_mask:0xf bank_mask:0xf
    v_add_f32 v105, v105, v19
    s_waitcnt vmcnt(24)
    v_mfma_f32_16x16x32_bf16 v[68:71], v[180:183], v[40:43], 0
    v_mov_b32_dpp v106, v64 quad_perm:[0,0,0,0] row_mask:0xf bank_mask:0xf
    v_mov_b32_dpp v19, v66 quad_perm:[2,2,2,2] row_mask:0xf bank_mask:0xf
    s_nop 0
    v_add_f32_dpp v106, v65, v106 quad_perm:[1,1,1,1] row_mask:0xf bank_mask:0xf
    v_add_f32_dpp v19, v67, v19 quad_perm:[3,3,3,3] row_mask:0xf bank_mask:0xf
    v_add_f32 v106, v106, v19
    s_waitcnt vmcnt(23)
    v_mfma_f32_16x16x32_bf16 v[64:67], v[184:187], v[40:43], 0
    v_mov_b32_dpp v107, v68 quad_perm:[0,0,0,0] row_mask:0xf bank_mask:0xf
    v_mov_b32_dpp v19, v70 quad_perm:[2,2,2,2] row_mask:0xf bank_mask:0xf
    s_nop 0
    v_add_f32_dpp v107, v69, v107 quad_perm:[1,1,1,1] row_mask:0xf bank_mask:0xf
    v_add_f32_dpp v19, v71, v19 quad_perm:[3,3,3,3] row_mask:0xf bank_mask:0xf
    v_add_f32 v107, v107, v19
    s_waitcnt vmcnt(22)
    v_mfma_f32_16x16x32_bf16 v[68:71], v[188:191], v[40:43], 0
    v_mov_b32_dpp v108, v64 quad_perm:[0,0,0,0] row_mask:0xf bank_mask:0xf
    v_mov_b32_dpp v19, v66 quad_perm:[2,2,2,2] row_mask:0xf bank_mask:0xf
    s_nop 0
    v_add_f32_dpp v108, v65, v108 quad_perm:[1,1,1,1] row_mask:0xf bank_mask:0xf
    v_add_f32_dpp v19, v67, v19 quad_perm:[3,3,3,3] row_mask:0xf bank_mask:0xf
    v_add_f32 v108, v108, v19
    s_waitcnt vmcnt(21)
    v_mfma_f32_16x16x32_bf16 v[64:67], v[192:195], v[40:43], 0
    v_mov_b32_dpp v109, v68 quad_perm:[0,0,0,0] row_mask:0xf bank_mask:0xf
    v_mov_b32_dpp v19, v70 quad_perm:[2,2,2,2] row_mask:0xf bank_mask:0xf
    s_nop 0
    v_add_f32_dpp v109, v69, v109 quad_perm:[1,1,1,1] row_mask:0xf bank_mask:0xf
    v_add_f32_dpp v19, v71, v19 quad_perm:[3,3,3,3] row_mask:0xf bank_mask:0xf
    v_add_f32 v109, v109, v19
    s_waitcnt vmcnt(20)
    v_mfma_f32_16x16x32_bf16 v[68:71], v[196:199], v[40:43], 0
    v_mov_b32_dpp v110, v64 quad_perm:[0,0,0,0] row_mask:0xf bank_mask:0xf
    v_mov_b32_dpp v19, v66 quad_perm:[2,2,2,2] row_mask:0xf bank_mask:0xf
    s_nop 0
    v_add_f32_dpp v110, v65, v110 quad_perm:[1,1,1,1] row_mask:0xf bank_mask:0xf
    v_add_f32_dpp v19, v67, v19 quad_perm:[3,3,3,3] row_mask:0xf bank_mask:0xf
    v_add_f32 v110, v110, v19
    s_waitcnt vmcnt(19)
    v_mfma_f32_16x16x32_bf16 v[64:67], v[200:203], v[40:43], 0
    v_mov_b32_dpp v111, v68 quad_perm:[0,0,0,0] row_mask:0xf bank_mask:0xf
    v_mov_b32_dpp v19, v70 quad_perm:[2,2,2,2] row_mask:0xf bank_mask:0xf
    s_nop 0
    v_add_f32_dpp v111, v69, v111 quad_perm:[1,1,1,1] row_mask:0xf bank_mask:0xf
    v_add_f32_dpp v19, v71, v19 quad_perm:[3,3,3,3] row_mask:0xf bank_mask:0xf
    v_add_f32 v111, v111, v19
    s_waitcnt vmcnt(18)
    v_mfma_f32_16x16x32_bf16 v[68:71], v[204:207], v[40:43], 0
    v_mov_b32_dpp v112, v64 quad_perm:[0,0,0,0] row_mask:0xf bank_mask:0xf
    v_mov_b32_dpp v19, v66 quad_perm:[2,2,2,2] row_mask:0xf bank_mask:0xf
    s_nop 0
    v_add_f32_dpp v112, v65, v112 quad_perm:[1,1,1,1] row_mask:0xf bank_mask:0xf
    v_add_f32_dpp v19, v67, v19 quad_perm:[3,3,3,3] row_mask:0xf bank_mask:0xf
    v_add_f32 v112, v112, v19
    s_waitcnt vmcnt(17)
    v_mfma_f32_16x16x32_bf16 v[64:67], v[208:211], v[40:43], 0
    v_mov_b32_dpp v113, v68 quad_perm:[0,0,0,0] row_mask:0xf bank_mask:0xf
    v_mov_b32_dpp v19, v70 quad_perm:[2,2,2,2] row_mask:0xf bank_mask:0xf
    s_nop 0
    v_add_f32_dpp v113, v69, v113 quad_perm:[1,1,1,1] row_mask:0xf bank_mask:0xf
    v_add_f32_dpp v19, v71, v19 quad_perm:[3,3,3,3] row_mask:0xf bank_mask:0xf
    v_add_f32 v113, v113, v19
    s_waitcnt vmcnt(16)
    v_mfma_f32_16x16x32_bf16 v[68:71], v[212:215], v[40:43], 0
    v_mov_b32_dpp v114, v64 quad_perm:[0,0,0,0] row_mask:0xf bank_mask:0xf
    v_mov_b32_dpp v19, v66 quad_perm:[2,2,2,2] row_mask:0xf bank_mask:0xf
    s_nop 0
    v_add_f32_dpp v114, v65, v114 quad_perm:[1,1,1,1] row_mask:0xf bank_mask:0xf
    v_add_f32_dpp v19, v67, v19 quad_perm:[3,3,3,3] row_mask:0xf bank_mask:0xf
    v_add_f32 v114, v114, v19
    s_waitcnt vmcnt(15)
    v_mfma_f32_16x16x32_bf16 v[64:67], v[216:219], v[40:43], 0
    v_mov_b32_dpp v115, v68 quad_perm:[0,0,0,0] row_mask:0xf bank_mask:0xf
    v_mov_b32_dpp v19, v70 quad_perm:[2,2,2,2] row_mask:0xf bank_mask:0xf
    s_nop 0
    v_add_f32_dpp v115, v69, v115 quad_perm:[1,1,1,1] row_mask:0xf bank_mask:0xf
    v_add_f32_dpp v19, v71, v19 quad_perm:[3,3,3,3] row_mask:0xf bank_mask:0xf
    v_add_f32 v115, v115, v19
    s_waitcnt vmcnt(14)
    v_mfma_f32_16x16x32_bf16 v[68:71], v[220:223], v[40:43], 0
    v_mov_b32_dpp v116, v64 quad_perm:[0,0,0,0] row_mask:0xf bank_mask:0xf
    v_mov_b32_dpp v19, v66 quad_perm:[2,2,2,2] row_mask:0xf bank_mask:0xf
    s_nop 0
    v_add_f32_dpp v116, v65, v116 quad_perm:[1,1,1,1] row_mask:0xf bank_mask:0xf
    v_add_f32_dpp v19, v67, v19 quad_perm:[3,3,3,3] row_mask:0xf bank_mask:0xf
    v_add_f32 v116, v116, v19
    s_waitcnt vmcnt(13)
    v_mfma_f32_16x16x32_bf16 v[64:67], v[224:227], v[40:43], 0
    v_mov_b32_dpp v117, v68 quad_perm:[0,0,0,0] row_mask:0xf bank_mask:0xf
    v_mov_b32_dpp v19, v70 quad_perm:[2,2,2,2] row_mask:0xf bank_mask:0xf
    s_nop 0
    v_add_f32_dpp v117, v69, v117 quad_perm:[1,1,1,1] row_mask:0xf bank_mask:0xf
    v_add_f32_dpp v19, v71, v19 quad_perm:[3,3,3,3] row_mask:0xf bank_mask:0xf
    v_add_f32 v117, v117, v19
    s_waitcnt vmcnt(12)
    v_mfma_f32_16x16x32_bf16 v[68:71], v[228:231], v[40:43], 0
    v_mov_b32_dpp v118, v64 quad_perm:[0,0,0,0] row_mask:0xf bank_mask:0xf
    v_mov_b32_dpp v19, v66 quad_perm:[2,2,2,2] row_mask:0xf bank_mask:0xf
    s_nop 0
    v_add_f32_dpp v118, v65, v118 quad_perm:[1,1,1,1] row_mask:0xf bank_mask:0xf
    v_add_f32_dpp v19, v67, v19 quad_perm:[3,3,3,3] row_mask:0xf bank_mask:0xf
    v_add_f32 v118, v118, v19
    s_waitcnt vmcnt(11)
    v_mfma_f32_16x16x32_bf16 v[64:67], v[232:235], v[40:43], 0
    v_mov_b32_dpp v119, v68 quad_perm:[0,0,0,0] row_mask:0xf bank_mask:0xf
    v_mov_b32_dpp v19, v70 quad_perm:[2,2,2,2] row_mask:0xf bank_mask:0xf
    s_nop 0
    v_add_f32_dpp v119, v69, v119 quad_perm:[1,1,1,1] row_mask:0xf bank_mask:0xf
    v_add_f32_dpp v19, v71, v19 quad_perm:[3,3,3,3] row_mask:0xf bank_mask:0xf
    v_add_f32 v119, v119, v19
    s_waitcnt vmcnt(10)
    v_mfma_f32_16x16x32_bf16 v[68:71], v[236:239], v[40:43], 0
    v_mov_b32_dpp v120, v64 quad_perm:[0,0,0,0] row_mask:0xf bank_mask:0xf
    v_mov_b32_dpp v19, v66 quad_perm:[2,2,2,2] row_mask:0xf bank_mask:0xf
    s_nop 0
    v_add_f32_dpp v120, v65, v120 quad_perm:[1,1,1,1] row_mask:0xf bank_mask:0xf
    v_add_f32_dpp v19, v67, v19 quad_perm:[3,3,3,3] row_mask:0xf bank_mask:0xf
    v_add_f32 v120, v120, v19
    s_waitcnt vmcnt(9)
    v_mfma_f32_16x16x32_bf16 v[64:67], v[240:243], v[40:43], 0
    v_mov_b32_dpp v121, v68 quad_perm:[0,0,0,0] row_mask:0xf bank_mask:0xf
    v_mov_b32_dpp v19, v70 quad_perm:[2,2,2,2] row_mask:0xf bank_mask:0xf
    s_nop 0
    v_add_f32_dpp v121, v69, v121 quad_perm:[1,1,1,1] row_mask:0xf bank_mask:0xf
    v_add_f32_dpp v19, v71, v19 quad_perm:[3,3,3,3] row_mask:0xf bank_mask:0xf
    v_add_f32 v121, v121, v19
    s_waitcnt vmcnt(8)
    v_mfma_f32_16x16x32_bf16 v[68:71], v[244:247], v[40:43], 0
    v_mov_b32_dpp v122, v64 quad_perm:[0,0,0,0] row_mask:0xf bank_mask:0xf
    v_mov_b32_dpp v19, v66 quad_perm:[2,2,2,2] row_mask:0xf bank_mask:0xf
    s_nop 0
    v_add_f32_dpp v122, v65, v122 quad_perm:[1,1,1,1] row_mask:0xf bank_mask:0xf
    v_add_f32_dpp v19, v67, v19 quad_perm:[3,3,3,3] row_mask:0xf bank_mask:0xf
    v_add_f32 v122, v122, v19
    s_waitcnt vmcnt(7)
    v_mfma_f32_16x16x32_bf16 v[64:67], v[136:139], v[40:43], 0
    v_mov_b32_dpp v123, v68 quad_perm:[0,0,0,0] row_mask:0xf bank_mask:0xf
    v_mov_b32_dpp v19, v70 quad_perm:[2,2,2,2] row_mask:0xf bank_mask:0xf
    s_nop 0
    v_add_f32_dpp v123, v69, v123 quad_perm:[1,1,1,1] row_mask:0xf bank_mask:0xf
    v_add_f32_dpp v19, v71, v19 quad_perm:[3,3,3,3] row_mask:0xf bank_mask:0xf
    v_add_f32 v123, v123, v19
    s_waitcnt vmcnt(6)
    v_mfma_f32_16x16x32_bf16 v[68:71], v[140:143], v[40:43], 0
    v_mov_b32_dpp v124, v64 quad_perm:[0,0,0,0] row_mask:0xf bank_mask:0xf
    v_mov_b32_dpp v19, v66 quad_perm:[2,2,2,2] row_mask:0xf bank_mask:0xf
    s_nop 0
    v_add_f32_dpp v124, v65, v124 quad_perm:[1,1,1,1] row_mask:0xf bank_mask:0xf
    v_add_f32_dpp v19, v67, v19 quad_perm:[3,3,3,3] row_mask:0xf bank_mask:0xf
    v_add_f32 v124, v124, v19
    s_waitcnt vmcnt(5)
    v_mfma_f32_16x16x32_bf16 v[64:67], v[144:147], v[40:43], 0
    v_xor_b32 v250, 0x34a00, v248
    buffer_load_dwordx4 v[168:171], v250, s[20:23], 0 offen nt
    v_mov_b32_dpp v125, v68 quad_perm:[0,0,0,0] row_mask:0xf bank_mask:0xf
    v_mov_b32_dpp v19, v70 quad_perm:[2,2,2,2] row_mask:0xf bank_mask:0xf
    s_nop 0
    v_add_f32_dpp v125, v69, v125 quad_perm:[1,1,1,1] row_mask:0xf bank_mask:0xf
    v_add_f32_dpp v19, v71, v19 quad_perm:[3,3,3,3] row_mask:0xf bank_mask:0xf
    v_add_f32 v125, v125, v19
    s_waitcnt vmcnt(5)
    v_mfma_f32_16x16x32_bf16 v[68:71], v[148:151], v[40:43], 0
    v_xor_b32 v251, 0x21300, v248
    buffer_load_dwordx4 v[172:175], v251, s[20:23], 0 offen nt
    v_mov_b32_dpp v126, v64 quad_perm:[0,0,0,0] row_mask:0xf bank_mask:0xf
    v_mov_b32_dpp v19, v66 quad_perm:[2,2,2,2] row_mask:0xf bank_mask:0xf
    s_nop 0
    v_add_f32_dpp v126, v65, v126 quad_perm:[1,1,1,1] row_mask:0xf bank_mask:0xf
    v_add_f32_dpp v19, v67, v19 quad_perm:[3,3,3,3] row_mask:0xf bank_mask:0xf
    v_add_f32 v126, v126, v19
    s_waitcnt vmcnt(5)
    v_mfma_f32_16x16x32_bf16 v[64:67], v[152:155], v[40:43], 0
    v_xor_b32 v250, 0x31a00, v248
    buffer_load_dwordx4 v[176:179], v250, s[20:23], 0 offen nt
    v_mov_b32_dpp v127, v68 quad_perm:[0,0,0,0] row_mask:0xf bank_mask:0xf
    v_mov_b32_dpp v19, v70 quad_perm:[2,2,2,2] row_mask:0xf bank_mask:0xf
    s_nop 0
    v_add_f32_dpp v127, v69, v127 quad_perm:[1,1,1,1] row_mask:0xf bank_mask:0xf
    v_add_f32_dpp v19, v71, v19 quad_perm:[3,3,3,3] row_mask:0xf bank_mask:0xf
    v_add_f32 v127, v127, v19
    s_waitcnt vmcnt(5)
    v_mfma_f32_16x16x32_bf16 v[68:71], v[156:159], v[40:43], 0
    v_xor_b32 v251, 0x24300, v248
    buffer_load_dwordx4 v[180:183], v251, s[20:23], 0 offen nt
    v_mov_b32_dpp v128, v64 quad_perm:[0,0,0,0] row_mask:0xf bank_mask:0xf
    v_mov_b32_dpp v19, v66 quad_perm:[2,2,2,2] row_mask:0xf bank_mask:0xf
    s_nop 0
    v_add_f32_dpp v128, v65, v128 quad_perm:[1,1,1,1] row_mask:0xf bank_mask:0xf
    v_add_f32_dpp v19, v67, v19 quad_perm:[3,3,3,3] row_mask:0xf bank_mask:0xf
    v_add_f32 v128, v128, v19
    s_waitcnt vmcnt(5)
    v_mfma_f32_16x16x32_bf16 v[64:67], v[160:163], v[40:43], 0
    buffer_load_dwordx4 v[184:187], v249, s[24:27], 0 offen nt
    v_mov_b32_dpp v129, v68 quad_perm:[0,0,0,0] row_mask:0xf bank_mask:0xf
    v_mov_b32_dpp v19, v70 quad_perm:[2,2,2,2] row_mask:0xf bank_mask:0xf
    s_nop 0
    v_add_f32_dpp v129, v69, v129 quad_perm:[1,1,1,1] row_mask:0xf bank_mask:0xf
    v_add_f32_dpp v19, v71, v19 quad_perm:[3,3,3,3] row_mask:0xf bank_mask:0xf
    v_add_f32 v129, v129, v19
    s_waitcnt vmcnt(5)
    v_mfma_f32_16x16x32_bf16 v[68:71], v[164:167], v[40:43], 0
    v_xor_b32 v251, 0x15900, v249
    buffer_load_dwordx4 v[188:191], v251, s[24:27], 0 offen nt
    v_mov_b32_dpp v130, v64 quad_perm:[0,0,0,0] row_mask:0xf bank_mask:0xf
    v_mov_b32_dpp v19, v66 quad_perm:[2,2,2,2] row_mask:0xf bank_mask:0xf
    s_nop 0
    v_add_f32_dpp v130, v65, v130 quad_perm:[1,1,1,1] row_mask:0xf bank_mask:0xf
    v_add_f32_dpp v19, v67, v19 quad_perm:[3,3,3,3] row_mask:0xf bank_mask:0xf
    v_add_f32 v130, v130, v19
    s_waitcnt vmcnt(5)
    v_mfma_f32_16x16x32_bf16 v[64:67], v[168:171], v[40:43], 0
    v_xor_b32 v250, 0x5000, v249
    buffer_load_dwordx4 v[192:195], v250, s[24:27], 0 offen nt
    v_mov_b32_dpp v131, v68 quad_perm:[0,0,0,0] row_mask:0xf bank_mask:0xf
    v_mov_b32_dpp v19, v70 quad_perm:[2,2,2,2] row_mask:0xf bank_mask:0xf
    s_nop 0
    v_add_f32_dpp v131, v69, v131 quad_perm:[1,1,1,1] row_mask:0xf bank_mask:0xf
    v_add_f32_dpp v19, v71, v19 quad_perm:[3,3,3,3] row_mask:0xf bank_mask:0xf
    v_add_f32 v131, v131, v19
    s_waitcnt vmcnt(5)
    v_mfma_f32_16x16x32_bf16 v[68:71], v[172:175], v[40:43], 0
    v_xor_b32 v251, 0x10900, v249
    buffer_load_dwordx4 v[196:199], v251, s[24:27], 0 offen nt
    v_mov_b32_dpp v132, v64 quad_perm:[0,0,0,0] row_mask:0xf bank_mask:0xf
    v_mov_b32_dpp v19, v66 quad_perm:[2,2,2,2] row_mask:0xf bank_mask:0xf
    s_nop 0
    v_add_f32_dpp v132, v65, v132 quad_perm:[1,1,1,1] row_mask:0xf bank_mask:0xf
    v_add_f32_dpp v19, v67, v19 quad_perm:[3,3,3,3] row_mask:0xf bank_mask:0xf
    v_add_f32 v132, v132, v19
    s_waitcnt vmcnt(5)
    v_mfma_f32_16x16x32_bf16 v[64:67], v[176:179], v[40:43], 0
    v_xor_b32 v250, 0x31000, v249
    buffer_load_dwordx4 v[200:203], v250, s[24:27], 0 offen nt
    v_mov_b32_dpp v133, v68 quad_perm:[0,0,0,0] row_mask:0xf bank_mask:0xf
    v_mov_b32_dpp v19, v70 quad_perm:[2,2,2,2] row_mask:0xf bank_mask:0xf
    s_nop 0
    v_add_f32_dpp v133, v69, v133 quad_perm:[1,1,1,1] row_mask:0xf bank_mask:0xf
    v_add_f32_dpp v19, v71, v19 quad_perm:[3,3,3,3] row_mask:0xf bank_mask:0xf
    v_add_f32 v133, v133, v19
    s_waitcnt vmcnt(5)
    v_mfma_f32_16x16x32_bf16 v[68:71], v[180:183], v[40:43], 0
    v_xor_b32 v251, 0x24900, v249
    buffer_load_dwordx4 v[204:207], v251, s[24:27], 0 offen nt
    v_mov_b32_dpp v134, v64 quad_perm:[0,0,0,0] row_mask:0xf bank_mask:0xf
    v_mov_b32_dpp v19, v66 quad_perm:[2,2,2,2] row_mask:0xf bank_mask:0xf
    s_nop 0
    v_add_f32_dpp v134, v65, v134 quad_perm:[1,1,1,1] row_mask:0xf bank_mask:0xf
    v_add_f32_dpp v19, v67, v19 quad_perm:[3,3,3,3] row_mask:0xf bank_mask:0xf
    v_add_f32 v134, v134, v19
    v_xor_b32 v250, 0x34000, v249
    buffer_load_dwordx4 v[208:211], v250, s[24:27], 0 offen nt
    v_xor_b32 v251, 0x21900, v249
    buffer_load_dwordx4 v[212:215], v251, s[24:27], 0 offen nt
    v_xor_b32 v250, 0x21c00, v249
    buffer_load_dwordx4 v[216:219], v250, s[24:27], 0 offen nt
    v_xor_b32 v251, 0x34500, v249
    buffer_load_dwordx4 v[220:223], v251, s[24:27], 0 offen nt
    v_xor_b32 v250, 0x24c00, v249
    buffer_load_dwordx4 v[224:227], v250, s[24:27], 0 offen nt
    v_xor_b32 v251, 0x31500, v249
    buffer_load_dwordx4 v[228:231], v251, s[24:27], 0 offen nt
    v_xor_b32 v250, 0x10c00, v249
    buffer_load_dwordx4 v[232:235], v250, s[24:27], 0 offen nt
    v_xor_b32 v251, 0x5500, v249
    buffer_load_dwordx4 v[236:239], v251, s[24:27], 0 offen nt
    v_xor_b32 v250, 0x15c00, v249
    buffer_load_dwordx4 v[240:243], v250, s[24:27], 0 offen nt
    v_xor_b32 v251, 0x500, v249
    buffer_load_dwordx4 v[244:247], v251, s[24:27], 0 offen nt
    v_xor_b32 v250, 0x24600, v249
    buffer_load_dwordx4 v[136:139], v250, s[24:27], 0 offen nt
    v_xor_b32 v251, 0x31f00, v249
    buffer_load_dwordx4 v[140:143], v251, s[24:27], 0 offen nt
    v_xor_b32 v250, 0x21600, v249
    buffer_load_dwordx4 v[144:147], v250, s[24:27], 0 offen nt
    v_xor_b32 v251, 0x34f00, v249
    buffer_load_dwordx4 v[148:151], v251, s[24:27], 0 offen nt
    v_xor_b32 v250, 0x15600, v249
    buffer_load_dwordx4 v[152:155], v250, s[24:27], 0 offen nt
    v_xor_b32 v251, 0xf00, v249
    buffer_load_dwordx4 v[156:159], v251, s[24:27], 0 offen nt
    v_xor_b32 v250, 0x10600, v249
    buffer_load_dwordx4 v[160:163], v250, s[24:27], 0 offen nt
    v_xor_b32 v251, 0x5f00, v249
    buffer_load_dwordx4 v[164:167], v251, s[24:27], 0 offen nt
    v_xor_b32 v250, 0x5a00, v249
    buffer_load_dwordx4 v[168:171], v250, s[24:27], 0 offen nt
    v_xor_b32 v251, 0x10300, v249
    buffer_load_dwordx4 v[172:175], v251, s[24:27], 0 offen nt
    v_xor_b32 v250, 0xa00, v249
    buffer_load_dwordx4 v[176:179], v250, s[24:27], 0 offen nt
    v_xor_b32 v251, 0x15300, v249
    buffer_load_dwordx4 v[180:183], v251, s[24:27], 0 offen nt
    v_mov_b32_dpp v135, v68 quad_perm:[0,0,0,0] row_mask:0xf bank_mask:0xf
    v_mov_b32_dpp v19, v70 quad_perm:[2,2,2,2] row_mask:0xf bank_mask:0xf
    s_nop 0
    v_add_f32_dpp v135, v69, v135 quad_perm:[1,1,1,1] row_mask:0xf bank_mask:0xf
    v_add_f32_dpp v19, v71, v19 quad_perm:[3,3,3,3] row_mask:0xf bank_mask:0xf
    v_add_f32 v135, v135, v19
    v_max3_f32 v12, v104, v105, v106
    v_max3_f32 v12, v12, v107, v108
    v_max3_f32 v12, v12, v109, v110
    v_max3_f32 v12, v12, v111, v112
    v_max3_f32 v12, v12, v113, v114
    v_max3_f32 v12, v12, v115, v116
    v_max3_f32 v12, v12, v117, v118
    v_max3_f32 v12, v12, v119, v120
    v_max3_f32 v12, v12, v121, v122
    v_max3_f32 v12, v12, v123, v124
    v_max3_f32 v12, v12, v125, v126
    v_max3_f32 v12, v12, v127, v128
    v_max3_f32 v12, v12, v129, v130
    v_max3_f32 v12, v12, v131, v132
    v_max3_f32 v12, v12, v133, v134
    v_max_f32 v12, v12, v135
    v_and_b32 v13, 12, v1
    ds_max_f32 v13, v12 offset:18432
    s_waitcnt lgkmcnt(0)
    s_barrier
    ds_read_b32 v12, v13 offset:18432
    s_waitcnt lgkmcnt(0)
    v_mul_f32 v12, s61, v12
    v_fma_f32 v104, v104, s61, -v12
    v_fma_f32 v105, v105, s61, -v12
    v_fma_f32 v106, v106, s61, -v12
    v_fma_f32 v107, v107, s61, -v12
    v_fma_f32 v108, v108, s61, -v12
    v_fma_f32 v109, v109, s61, -v12
    v_fma_f32 v110, v110, s61, -v12
    v_fma_f32 v111, v111, s61, -v12
    v_fma_f32 v112, v112, s61, -v12
    v_fma_f32 v113, v113, s61, -v12
    v_fma_f32 v114, v114, s61, -v12
    v_fma_f32 v115, v115, s61, -v12
    v_fma_f32 v116, v116, s61, -v12
    v_fma_f32 v117, v117, s61, -v12
    v_fma_f32 v118, v118, s61, -v12
    v_fma_f32 v119, v119, s61, -v12
    v_fma_f32 v120, v120, s61, -v12
    v_fma_f32 v121, v121, s61, -v12
    v_fma_f32 v122, v122, s61, -v12
    v_fma_f32 v123, v123, s61, -v12
    v_fma_f32 v124, v124, s61, -v12
    v_fma_f32 v125, v125, s61, -v12
    v_fma_f32 v126, v126, s61, -v12
    v_fma_f32 v127, v127, s61, -v12
    v_fma_f32 v128, v128, s61, -v12
    v_fma_f32 v129, v129, s61, -v12
    v_fma_f32 v130, v130, s61, -v12
    v_fma_f32 v131, v131, s61, -v12
    v_fma_f32 v132, v132, s61, -v12
    v_fma_f32 v133, v133, s61, -v12
    v_fma_f32 v134, v134, s61, -v12
    v_fma_f32 v135, v135, s61, -v12
    v_exp_f32 v104, v104
    v_exp_f32 v105, v105
    v_exp_f32 v106, v106
    v_exp_f32 v107, v107
    v_exp_f32 v108, v108
    v_exp_f32 v109, v109
    v_exp_f32 v110, v110
    v_exp_f32 v111, v111
    v_exp_f32 v112, v112
    v_exp_f32 v113, v113
    v_exp_f32 v114, v114
    v_exp_f32 v115, v115
    v_exp_f32 v116, v116
    v_exp_f32 v117, v117
    v_exp_f32 v118, v118
    v_exp_f32 v119, v119
    v_exp_f32 v120, v120
    v_exp_f32 v121, v121
    v_exp_f32 v122, v122
    v_exp_f32 v123, v123
    v_exp_f32 v124, v124
    v_exp_f32 v125, v125
    v_exp_f32 v126, v126
    v_exp_f32 v127, v127
    v_exp_f32 v128, v128
    v_exp_f32 v129, v129
    v_exp_f32 v130, v130
    v_exp_f32 v131, v131
    v_exp_f32 v132, v132
    v_exp_f32 v133, v133
    v_exp_f32 v134, v134
    v_exp_f32 v135, v135
    v_add_f32 v14, v104, v105
    v_add_f32 v14, v14, v106
    v_add_f32 v14, v14, v107
    v_add_f32 v14, v14, v108
    v_add_f32 v14, v14, v109
    v_add_f32 v14, v14, v110
    v_add_f32 v14, v14, v111
    v_add_f32 v14, v14, v112
    v_add_f32 v14, v14, v113
    v_add_f32 v14, v14, v114
    v_add_f32 v14, v14, v115
    v_add_f32 v14, v14, v116
    v_add_f32 v14, v14, v117
    v_add_f32 v14, v14, v118
    v_add_f32 v14, v14, v119
    v_add_f32 v14, v14, v120
    v_add_f32 v14, v14, v121
    v_add_f32 v14, v14, v122
    v_add_f32 v14, v14, v123
    v_add_f32 v14, v14, v124
    v_add_f32 v14, v14, v125
    v_add_f32 v14, v14, v126
    v_add_f32 v14, v14, v127
    v_add_f32 v14, v14, v128
    v_add_f32 v14, v14, v129
    v_add_f32 v14, v14, v130
    v_add_f32 v14, v14, v131
    v_add_f32 v14, v14, v132
    v_add_f32 v14, v14, v133
    v_add_f32 v14, v14, v134
    v_add_f32 v14, v14, v135
    v_cvt_pk_bf16_f32 v104, v104, v104
    v_cvt_pk_bf16_f32 v105, v105, v105
    v_cvt_pk_bf16_f32 v106, v106, v106
    v_cvt_pk_bf16_f32 v107, v107, v107
    v_cvt_pk_bf16_f32 v108, v108, v108
    v_cvt_pk_bf16_f32 v109, v109, v109
    v_cvt_pk_bf16_f32 v110, v110, v110
    v_cvt_pk_bf16_f32 v111, v111, v111
    v_cvt_pk_bf16_f32 v112, v112, v112
    v_cvt_pk_bf16_f32 v113, v113, v113
    v_cvt_pk_bf16_f32 v114, v114, v114
    v_cvt_pk_bf16_f32 v115, v115, v115
    v_cvt_pk_bf16_f32 v116, v116, v116
    v_cvt_pk_bf16_f32 v117, v117, v117
    v_cvt_pk_bf16_f32 v118, v118, v118
    v_cvt_pk_bf16_f32 v119, v119, v119
    v_cvt_pk_bf16_f32 v120, v120, v120
    v_cvt_pk_bf16_f32 v121, v121, v121
    v_cvt_pk_bf16_f32 v122, v122, v122
    v_cvt_pk_bf16_f32 v123, v123, v123
    v_cvt_pk_bf16_f32 v124, v124, v124
    v_cvt_pk_bf16_f32 v125, v125, v125
    v_cvt_pk_bf16_f32 v126, v126, v126
    v_cvt_pk_bf16_f32 v127, v127, v127
    v_cvt_pk_bf16_f32 v128, v128, v128
    v_cvt_pk_bf16_f32 v129, v129, v129
    v_cvt_pk_bf16_f32 v130, v130, v130
    v_cvt_pk_bf16_f32 v131, v131, v131
    v_cvt_pk_bf16_f32 v132, v132, v132
    v_cvt_pk_bf16_f32 v133, v133, v133
    v_cvt_pk_bf16_f32 v134, v134, v134
    v_cvt_pk_bf16_f32 v135, v135, v135
    v_mul_f32 v14, 0x3e800000, v14
    ds_add_f32 v13, v14 offset:18448
    v_and_b32 v22, v104, v6
    v_and_b32 v23, v104, v7
    s_waitcnt vmcnt(27)
    s_nop 0
    v_mfma_f32_16x16x32_bf16 v[56:59], v[22:25], v[184:187], 0
    v_mfma_f32_16x16x32_bf16 v[60:63], v[20:23], v[184:187], 0
    v_and_b32 v26, v105, v6
    v_and_b32 v27, v105, v7
    s_waitcnt vmcnt(26)
    s_nop 0
    v_mfma_f32_16x16x32_bf16 v[56:59], v[26:29], v[188:191], v[56:59]
    v_mfma_f32_16x16x32_bf16 v[60:63], v[24:27], v[188:191], v[60:63]
    v_and_b32 v30, v106, v6
    v_and_b32 v31, v106, v7
    s_waitcnt vmcnt(25)
    s_nop 0
    v_mfma_f32_16x16x32_bf16 v[56:59], v[30:33], v[192:195], v[56:59]
    v_mfma_f32_16x16x32_bf16 v[60:63], v[28:31], v[192:195], v[60:63]
    v_and_b32 v34, v107, v6
    v_and_b32 v35, v107, v7
    s_waitcnt vmcnt(24)
    s_nop 0
    v_mfma_f32_16x16x32_bf16 v[56:59], v[34:37], v[196:199], v[56:59]
    v_mfma_f32_16x16x32_bf16 v[60:63], v[32:35], v[196:199], v[60:63]
    v_and_b32 v22, v108, v6
    v_and_b32 v23, v108, v7
    s_waitcnt vmcnt(23)
    s_nop 0
    v_mfma_f32_16x16x32_bf16 v[56:59], v[22:25], v[200:203], v[56:59]
    v_mfma_f32_16x16x32_bf16 v[60:63], v[20:23], v[200:203], v[60:63]
    v_and_b32 v26, v109, v6
    v_and_b32 v27, v109, v7
    s_waitcnt vmcnt(22)
    s_nop 0
    v_mfma_f32_16x16x32_bf16 v[56:59], v[26:29], v[204:207], v[56:59]
    v_mfma_f32_16x16x32_bf16 v[60:63], v[24:27], v[204:207], v[60:63]
    v_and_b32 v30, v110, v6
    v_and_b32 v31, v110, v7
    s_waitcnt vmcnt(21)
    s_nop 0
    v_mfma_f32_16x16x32_bf16 v[56:59], v[30:33], v[208:211], v[56:59]
    v_mfma_f32_16x16x32_bf16 v[60:63], v[28:31], v[208:211], v[60:63]
    v_and_b32 v34, v111, v6
    v_and_b32 v35, v111, v7
    s_waitcnt vmcnt(20)
    s_nop 0
    v_mfma_f32_16x16x32_bf16 v[56:59], v[34:37], v[212:215], v[56:59]
    v_mfma_f32_16x16x32_bf16 v[60:63], v[32:35], v[212:215], v[60:63]
    v_and_b32 v22, v112, v6
    v_and_b32 v23, v112, v7
    s_waitcnt vmcnt(19)
    s_nop 0
    v_mfma_f32_16x16x32_bf16 v[56:59], v[22:25], v[216:219], v[56:59]
    v_mfma_f32_16x16x32_bf16 v[60:63], v[20:23], v[216:219], v[60:63]
    v_and_b32 v26, v113, v6
    v_and_b32 v27, v113, v7
    s_waitcnt vmcnt(18)
    s_nop 0
    v_mfma_f32_16x16x32_bf16 v[56:59], v[26:29], v[220:223], v[56:59]
    v_mfma_f32_16x16x32_bf16 v[60:63], v[24:27], v[220:223], v[60:63]
    v_and_b32 v30, v114, v6
    v_and_b32 v31, v114, v7
    s_waitcnt vmcnt(17)
    s_nop 0
    v_mfma_f32_16x16x32_bf16 v[56:59], v[30:33], v[224:227], v[56:59]
    v_mfma_f32_16x16x32_bf16 v[60:63], v[28:31], v[224:227], v[60:63]
    v_and_b32 v34, v115, v6
    v_and_b32 v35, v115, v7
    s_waitcnt vmcnt(16)
    s_nop 0
    v_mfma_f32_16x16x32_bf16 v[56:59], v[34:37], v[228:231], v[56:59]
    v_mfma_f32_16x16x32_bf16 v[60:63], v[32:35], v[228:231], v[60:63]
    v_and_b32 v22, v116, v6
    v_and_b32 v23, v116, v7
    s_waitcnt vmcnt(15)
    s_nop 0
    v_mfma_f32_16x16x32_bf16 v[56:59], v[22:25], v[232:235], v[56:59]
    v_mfma_f32_16x16x32_bf16 v[60:63], v[20:23], v[232:235], v[60:63]
    v_and_b32 v26, v117, v6
    v_and_b32 v27, v117, v7
    s_waitcnt vmcnt(14)
    s_nop 0
    v_mfma_f32_16x16x32_bf16 v[56:59], v[26:29], v[236:239], v[56:59]
    v_mfma_f32_16x16x32_bf16 v[60:63], v[24:27], v[236:239], v[60:63]
    v_and_b32 v30, v118, v6
    v_and_b32 v31, v118, v7
    s_waitcnt vmcnt(13)
    s_nop 0
    v_mfma_f32_16x16x32_bf16 v[56:59], v[30:33], v[240:243], v[56:59]
    v_mfma_f32_16x16x32_bf16 v[60:63], v[28:31], v[240:243], v[60:63]
    v_and_b32 v34, v119, v6
    v_and_b32 v35, v119, v7
    s_waitcnt vmcnt(12)
    s_nop 0
    v_mfma_f32_16x16x32_bf16 v[56:59], v[34:37], v[244:247], v[56:59]
    v_mfma_f32_16x16x32_bf16 v[60:63], v[32:35], v[244:247], v[60:63]
    v_and_b32 v22, v120, v6
    v_and_b32 v23, v120, v7
    s_waitcnt vmcnt(11)
    s_nop 0
    v_mfma_f32_16x16x32_bf16 v[56:59], v[22:25], v[136:139], v[56:59]
    v_mfma_f32_16x16x32_bf16 v[60:63], v[20:23], v[136:139], v[60:63]
    v_and_b32 v26, v121, v6
    v_and_b32 v27, v121, v7
    s_waitcnt vmcnt(10)
    s_nop 0
    v_mfma_f32_16x16x32_bf16 v[56:59], v[26:29], v[140:143], v[56:59]
    v_mfma_f32_16x16x32_bf16 v[60:63], v[24:27], v[140:143], v[60:63]
    v_and_b32 v30, v122, v6
    v_and_b32 v31, v122, v7
    s_waitcnt vmcnt(9)
    s_nop 0
    v_mfma_f32_16x16x32_bf16 v[56:59], v[30:33], v[144:147], v[56:59]
    v_mfma_f32_16x16x32_bf16 v[60:63], v[28:31], v[144:147], v[60:63]
    v_and_b32 v34, v123, v6
    v_and_b32 v35, v123, v7
    s_waitcnt vmcnt(8)
    s_nop 0
    v_mfma_f32_16x16x32_bf16 v[56:59], v[34:37], v[148:151], v[56:59]
    v_mfma_f32_16x16x32_bf16 v[60:63], v[32:35], v[148:151], v[60:63]
    v_and_b32 v22, v124, v6
    v_and_b32 v23, v124, v7
    s_waitcnt vmcnt(7)
    s_nop 0
    v_mfma_f32_16x16x32_bf16 v[56:59], v[22:25], v[152:155], v[56:59]
    v_mfma_f32_16x16x32_bf16 v[60:63], v[20:23], v[152:155], v[60:63]
    v_and_b32 v26, v125, v6
    v_and_b32 v27, v125, v7
    s_waitcnt vmcnt(6)
    s_nop 0
    v_mfma_f32_16x16x32_bf16 v[56:59], v[26:29], v[156:159], v[56:59]
    v_mfma_f32_16x16x32_bf16 v[60:63], v[24:27], v[156:159], v[60:63]
    v_and_b32 v30, v126, v6
    v_and_b32 v31, v126, v7
    s_waitcnt vmcnt(5)
    s_nop 0
    v_mfma_f32_16x16x32_bf16 v[56:59], v[30:33], v[160:163], v[56:59]
    v_mfma_f32_16x16x32_bf16 v[60:63], v[28:31], v[160:163], v[60:63]
    v_xor_b32 v250, 0x34a00, v249
    buffer_load_dwordx4 v[184:187], v250, s[24:27], 0 offen nt
    v_and_b32 v34, v127, v6
    v_and_b32 v35, v127, v7
    s_waitcnt vmcnt(5)
    s_nop 0
    v_mfma_f32_16x16x32_bf16 v[56:59], v[34:37], v[164:167], v[56:59]
    v_mfma_f32_16x16x32_bf16 v[60:63], v[32:35], v[164:167], v[60:63]
    v_xor_b32 v251, 0x21300, v249
    buffer_load_dwordx4 v[188:191], v251, s[24:27], 0 offen nt
    v_and_b32 v22, v128, v6
    v_and_b32 v23, v128, v7
    s_waitcnt vmcnt(5)
    s_nop 0
    v_mfma_f32_16x16x32_bf16 v[56:59], v[22:25], v[168:171], v[56:59]
    v_mfma_f32_16x16x32_bf16 v[60:63], v[20:23], v[168:171], v[60:63]
    v_xor_b32 v250, 0x31a00, v249
    buffer_load_dwordx4 v[192:195], v250, s[24:27], 0 offen nt
    v_and_b32 v26, v129, v6
    v_and_b32 v27, v129, v7
    s_waitcnt vmcnt(5)
    s_nop 0
    v_mfma_f32_16x16x32_bf16 v[56:59], v[26:29], v[172:175], v[56:59]
    v_mfma_f32_16x16x32_bf16 v[60:63], v[24:27], v[172:175], v[60:63]
    v_xor_b32 v251, 0x24300, v249
    buffer_load_dwordx4 v[196:199], v251, s[24:27], 0 offen nt
    v_and_b32 v30, v130, v6
    v_and_b32 v31, v130, v7
    s_waitcnt vmcnt(5)
    s_nop 0
    v_mfma_f32_16x16x32_bf16 v[56:59], v[30:33], v[176:179], v[56:59]
    v_mfma_f32_16x16x32_bf16 v[60:63], v[28:31], v[176:179], v[60:63]
    buffer_load_dwordx4 v[200:203], v5, s[32:35], s62 offen
    v_and_b32 v34, v131, v6
    v_and_b32 v35, v131, v7
    s_waitcnt vmcnt(5)
    s_nop 0
    v_mfma_f32_16x16x32_bf16 v[56:59], v[34:37], v[180:183], v[56:59]
    v_mfma_f32_16x16x32_bf16 v[60:63], v[32:35], v[180:183], v[60:63]
    v_xor_b32 v253, 0x2000, v5
    buffer_load_dwordx4 v[204:207], v253, s[32:35], s62 offen
    v_and_b32 v22, v132, v6
    v_and_b32 v23, v132, v7
    s_waitcnt vmcnt(5)
    s_nop 0
    v_mfma_f32_16x16x32_bf16 v[56:59], v[22:25], v[184:187], v[56:59]
    v_mfma_f32_16x16x32_bf16 v[60:63], v[20:23], v[184:187], v[60:63]
    v_xor_b32 v252, 0x4000, v5
    buffer_load_dwordx4 v[208:211], v252, s[32:35], s62 offen
    v_and_b32 v26, v133, v6
    v_and_b32 v27, v133, v7
    s_waitcnt vmcnt(5)
    s_nop 0
    v_mfma_f32_16x16x32_bf16 v[56:59], v[26:29], v[188:191], v[56:59]
    v_mfma_f32_16x16x32_bf16 v[60:63], v[24:27], v[188:191], v[60:63]
    v_xor_b32 v253, 0x6000, v5
    buffer_load_dwordx4 v[212:215], v253, s[32:35], s62 offen
    v_and_b32 v30, v134, v6
    v_and_b32 v31, v134, v7
    s_waitcnt vmcnt(5)
    s_nop 0
    v_mfma_f32_16x16x32_bf16 v[56:59], v[30:33], v[192:195], v[56:59]
    v_mfma_f32_16x16x32_bf16 v[60:63], v[28:31], v[192:195], v[60:63]
    v_xor_b32 v252, 0x8000, v5
    buffer_load_dwordx4 v[216:219], v252, s[32:35], s62 offen
    v_and_b32 v34, v135, v6
    v_and_b32 v35, v135, v7
    s_waitcnt vmcnt(5)
    s_nop 0
    v_mfma_f32_16x16x32_bf16 v[56:59], v[34:37], v[196:199], v[56:59]
    v_mfma_f32_16x16x32_bf16 v[60:63], v[32:35], v[196:199], v[60:63]
    v_xor_b32 v253, 0xa000, v5
    buffer_load_dwordx4 v[220:223], v253, s[32:35], s62 offen
    v_xor_b32 v252, 0xc000, v5
    buffer_load_dwordx4 v[224:227], v252, s[32:35], s62 offen
    v_xor_b32 v253, 0xe000, v5
    buffer_load_dwordx4 v[228:231], v253, s[32:35], s62 offen
    v_xor_b32 v252, 0x10000, v5
    buffer_load_dwordx4 v[232:235], v252, s[32:35], s62 offen
    v_xor_b32 v253, 0x12000, v5
    buffer_load_dwordx4 v[236:239], v253, s[32:35], s62 offen
    v_xor_b32 v252, 0x14000, v5
    buffer_load_dwordx4 v[240:243], v252, s[32:35], s62 offen
    v_xor_b32 v253, 0x16000, v5
    buffer_load_dwordx4 v[244:247], v253, s[32:35], s62 offen
    v_xor_b32 v252, 0x18000, v5
    buffer_load_dwordx4 v[136:139], v252, s[32:35], s62 offen
    v_xor_b32 v253, 0x1a000, v5
    buffer_load_dwordx4 v[140:143], v253, s[32:35], s62 offen
    v_xor_b32 v252, 0x1c000, v5
    buffer_load_dwordx4 v[144:147], v252, s[32:35], s62 offen
    v_xor_b32 v253, 0x1e000, v5
    buffer_load_dwordx4 v[148:151], v253, s[32:35], s62 offen
    v_xor_b32 v252, 0x20000, v5
    buffer_load_dwordx4 v[152:155], v252, s[32:35], s62 offen
    v_xor_b32 v253, 0x22000, v5
    buffer_load_dwordx4 v[156:159], v253, s[32:35], s62 offen
    v_xor_b32 v252, 0x24000, v5
    buffer_load_dwordx4 v[160:163], v252, s[32:35], s62 offen
    v_xor_b32 v253, 0x26000, v5
    buffer_load_dwordx4 v[164:167], v253, s[32:35], s62 offen
    v_xor_b32 v252, 0x28000, v5
    buffer_load_dwordx4 v[168:171], v252, s[32:35], s62 offen
    v_xor_b32 v253, 0x2a000, v5
    buffer_load_dwordx4 v[172:175], v253, s[32:35], s62 offen
    v_xor_b32 v252, 0x2c000, v5
    buffer_load_dwordx4 v[176:179], v252, s[32:35], s62 offen
    v_xor_b32 v253, 0x2e000, v5
    buffer_load_dwordx4 v[180:183], v253, s[32:35], s62 offen
    v_xor_b32 v252, 0x30000, v5
    buffer_load_dwordx4 v[184:187], v252, s[32:35], s62 offen
    v_xor_b32 v253, 0x32000, v5
    buffer_load_dwordx4 v[188:191], v253, s[32:35], s62 offen
    v_xor_b32 v252, 0x34000, v5
    buffer_load_dwordx4 v[192:195], v252, s[32:35], s62 offen
    v_xor_b32 v253, 0x36000, v5
    buffer_load_dwordx4 v[196:199], v253, s[32:35], s62 offen
    v_lshlrev_b32 v12, 2, v1
    ds_add_f32 v12, v56 offset:16384
    ds_add_f32 v12, v57 offset:16640
    ds_add_f32 v12, v58 offset:16896
    ds_add_f32 v12, v59 offset:17152
    ds_add_f32 v12, v60 offset:17408
    ds_add_f32 v12, v61 offset:17664
    ds_add_f32 v12, v62 offset:17920
    ds_add_f32 v12, v63 offset:18176
    v_bfe_u32 v13, v1, 3, 1
    v_lshlrev_b32 v13, 10, v13
    v_lshrrev_b32 v14, 4, v1
    v_lshl_add_u32 v13, v14, 8, v13
    s_lshl_b32 s46, s60, 6
    s_lshl_b32 s47, s60, 2
    v_and_b32 v14, 1, v14
    v_lshl_add_u32 v13, v14, 6, v13
    v_lshlrev_b32 v14, 2, v14
    s_xor_b32 s48, s46, 0
    v_xor_b32 v40, s48, v13
    s_xor_b32 s48, s47, 0
    v_xor_b32 v44, s48, v14
    s_xor_b32 s48, s46, 64
    v_xor_b32 v41, s48, v13
    s_xor_b32 s48, s47, 4
    v_xor_b32 v45, s48, v14
    s_xor_b32 s48, s46, 128
    v_xor_b32 v42, s48, v13
    s_xor_b32 s48, s47, 8
    v_xor_b32 v46, s48, v14
    s_xor_b32 s48, s46, 192
    v_xor_b32 v43, s48, v13
    s_xor_b32 s48, s47, 12
    v_xor_b32 v47, s48, v14
    s_waitcnt lgkmcnt(0)
    s_barrier
    ds_read_b32 v68, v44 offset:18448
    ds_read_b32 v69, v45 offset:18448
    ds_read_b32 v70, v46 offset:18448
    ds_read_b32 v71, v47 offset:18448
    ds_read_b128 v[104:107], v40 offset:16384
    ds_read_b128 v[108:111], v40 offset:16400
    ds_read_b128 v[112:115], v40 offset:16416
    ds_read_b128 v[116:119], v40 offset:16432
    ds_read_b128 v[120:123], v41 offset:16384
    ds_read_b128 v[124:127], v41 offset:16400
    ds_read_b128 v[128:131], v41 offset:16416
    ds_read_b128 v[132:135], v41 offset:16432
    s_waitcnt lgkmcnt(0)
    v_rcp_f32 v68, v68
    v_rcp_f32 v69, v69
    v_rcp_f32 v70, v70
    v_rcp_f32 v71, v71
    v_mul_f32 v104, v104, v68
    v_mul_f32 v105, v105, v68
    v_mul_f32 v106, v106, v68
    v_mul_f32 v107, v107, v68
    v_mul_f32 v108, v108, v68
    v_mul_f32 v109, v109, v68
    v_mul_f32 v110, v110, v68
    v_mul_f32 v111, v111, v68
    v_mul_f32 v112, v112, v68
    v_mul_f32 v113, v113, v68
    v_mul_f32 v114, v114, v68
    v_mul_f32 v115, v115, v68
    v_mul_f32 v116, v116, v68
    v_mul_f32 v117, v117, v68
    v_mul_f32 v118, v118, v68
    v_mul_f32 v119, v119, v68
    v_mul_f32 v120, v120, v69
    v_mul_f32 v121, v121, v69
    v_mul_f32 v122, v122, v69
    v_mul_f32 v123, v123, v69
    v_mul_f32 v124, v124, v69
    v_mul_f32 v125, v125, v69
    v_mul_f32 v126, v126, v69
    v_mul_f32 v127, v127, v69
    v_mul_f32 v128, v128, v69
    v_mul_f32 v129, v129, v69
    v_mul_f32 v130, v130, v69
    v_mul_f32 v131, v131, v69
    v_mul_f32 v132, v132, v69
    v_mul_f32 v133, v133, v69
    v_mul_f32 v134, v134, v69
    v_mul_f32 v135, v135, v69
    v_cvt_pk_bf16_f32 v72, v104, v105
    v_cvt_pk_bf16_f32 v73, v106, v107
    v_cvt_pk_bf16_f32 v74, v108, v109
    v_cvt_pk_bf16_f32 v75, v110, v111
    v_cvt_pk_bf16_f32 v76, v112, v113
    v_cvt_pk_bf16_f32 v77, v114, v115
    v_cvt_pk_bf16_f32 v78, v116, v117
    v_cvt_pk_bf16_f32 v79, v118, v119
    v_cvt_pk_bf16_f32 v80, v120, v121
    v_cvt_pk_bf16_f32 v81, v122, v123
    v_cvt_pk_bf16_f32 v82, v124, v125
    v_cvt_pk_bf16_f32 v83, v126, v127
    v_cvt_pk_bf16_f32 v84, v128, v129
    v_cvt_pk_bf16_f32 v85, v130, v131
    v_cvt_pk_bf16_f32 v86, v132, v133
    v_cvt_pk_bf16_f32 v87, v134, v135
    ds_read_b128 v[104:107], v42 offset:16384
    ds_read_b128 v[108:111], v42 offset:16400
    ds_read_b128 v[112:115], v42 offset:16416
    ds_read_b128 v[116:119], v42 offset:16432
    ds_read_b128 v[120:123], v43 offset:16384
    ds_read_b128 v[124:127], v43 offset:16400
    ds_read_b128 v[128:131], v43 offset:16416
    ds_read_b128 v[132:135], v43 offset:16432
    s_waitcnt lgkmcnt(0)
    v_mul_f32 v104, v104, v70
    v_mul_f32 v105, v105, v70
    v_mul_f32 v106, v106, v70
    v_mul_f32 v107, v107, v70
    v_mul_f32 v108, v108, v70
    v_mul_f32 v109, v109, v70
    v_mul_f32 v110, v110, v70
    v_mul_f32 v111, v111, v70
    v_mul_f32 v112, v112, v70
    v_mul_f32 v113, v113, v70
    v_mul_f32 v114, v114, v70
    v_mul_f32 v115, v115, v70
    v_mul_f32 v116, v116, v70
    v_mul_f32 v117, v117, v70
    v_mul_f32 v118, v118, v70
    v_mul_f32 v119, v119, v70
    v_mul_f32 v120, v120, v71
    v_mul_f32 v121, v121, v71
    v_mul_f32 v122, v122, v71
    v_mul_f32 v123, v123, v71
    v_mul_f32 v124, v124, v71
    v_mul_f32 v125, v125, v71
    v_mul_f32 v126, v126, v71
    v_mul_f32 v127, v127, v71
    v_mul_f32 v128, v128, v71
    v_mul_f32 v129, v129, v71
    v_mul_f32 v130, v130, v71
    v_mul_f32 v131, v131, v71
    v_mul_f32 v132, v132, v71
    v_mul_f32 v133, v133, v71
    v_mul_f32 v134, v134, v71
    v_mul_f32 v135, v135, v71
    v_cvt_pk_bf16_f32 v88, v104, v105
    v_cvt_pk_bf16_f32 v89, v106, v107
    v_cvt_pk_bf16_f32 v90, v108, v109
    v_cvt_pk_bf16_f32 v91, v110, v111
    v_cvt_pk_bf16_f32 v92, v112, v113
    v_cvt_pk_bf16_f32 v93, v114, v115
    v_cvt_pk_bf16_f32 v94, v116, v117
    v_cvt_pk_bf16_f32 v95, v118, v119
    v_cvt_pk_bf16_f32 v96, v120, v121
    v_cvt_pk_bf16_f32 v97, v122, v123
    v_cvt_pk_bf16_f32 v98, v124, v125
    v_cvt_pk_bf16_f32 v99, v126, v127
    v_cvt_pk_bf16_f32 v100, v128, v129
    v_cvt_pk_bf16_f32 v101, v130, v131
    v_cvt_pk_bf16_f32 v102, v132, v133
    v_cvt_pk_bf16_f32 v103, v134, v135
    s_mul_i32 s68, s67, 0x9e3779b1
    s_add_u32 s68, s68, 0x7f4a7c15
    v_and_b32 v12, 15, v1
    v_lshlrev_b32 v17, 4, v12
    v_and_b32 v12, 32, v1
    v_lshl_add_u32 v17, v12, 3, v17
    v_and_b32 v12, 16, v1
    v_lshlrev_b32 v12, 23, v12
    v_add_u32 v17, v17, v12
    v_mov_b32 v65, s68
    v_mov_b32 v67, s68
    s_lshl_b32 s49, s40, 3
    s_add_u32 s49, s49, s41
    s_lshl_b32 s49, s49, 12
    s_lshl_b32 s63, s3, 9
    s_add_u32 s49, s49, s63
    s_add_u32 s49, s49, 1589248
    s_mov_b32 s16, s64
    s_and_b32 s17, s65, 0xffff
    s_mov_b32 s18, 0x2000
    s_mov_b32 s19, 0x00020000
    s_lshl_b32 s48, s40, 10
    s_lshl_b32 s46, s3, 7
    s_add_u32 s48, s48, s46
    s_add_u32 s48, s48, 1585152
    v_mov_b32 v117, 0
    buffer_load_dword v116, v117, s[36:39], s48 offen sc1
    v_mov_b32 v104, s40
    v_and_b32 v12, 15, v1
    v_lshlrev_b32 v18, 4, v12
    v_and_b32 v12, 32, v1
    v_lshl_add_u32 v18, v12, 3, v18
    v_cmp_eq_u32 s[94:95], 0, v104
    v_cmp_eq_u32 s[96:97], 3, v104
    v_mov_b32 v106, 0x1b0000
    v_bfe_u32 v12, v1, 0, 4
    v_lshl_or_b32 v106, v12, 3, v106
    v_bfe_u32 v12, v1, 5, 1
    v_lshl_or_b32 v106, v12, 7, v106
    v_bfe_u32 v12, v104, 0, 2
    v_lshl_or_b32 v106, v12, 12, v106
    v_and_b32 v12, 7, v1
    v_lshlrev_b32 v12, 4, v12
    v_lshl_add_u32 v107, v104, 11, v12
    v_lshrrev_b32 v12, 5, v1
    v_lshl_add_u32 v107, v12, 3, v107
    v_bfe_u32 v12, v1, 3, 1
    v_lshl_add_u32 v107, v12, 2, v107
    s_or_b64 vcc, s[94:95], s[96:97]
    v_mov_b32 v110, 0x60
    v_cndmask_b32 v110, v110, 64, vcc
    v_add_u32 v108, 7, v110
    v_lshlrev_b32 v112, 2, v104
    v_add_u32 v112, 0x182000, v112
    v_mov_b32 v115, 0x8000000
    s_mov_b32 s64, 0
    s_bfe_u32 s46, s3, 0x30000
    s_lshl_b32 s46, s46, 9
    s_or_b32 s64, s64, s46
    s_mov_b32 s46, 0x4b800000
    s_mov_b32 s47, 0xffffc000
    s_mov_b32 s50, 0x2f800000
    s_mov_b32 s51, 0x76ffffff
    s_mov_b32 s92, 0xffff
    s_mov_b32 s93, 0xffff
    v_add_u32 v12, 0x4000, v106
    v_cndmask_b32 v106, v106, v12, s[92:93]
    v_add_u32 v12, 0x400, v107
    v_cndmask_b32 v107, v107, v12, s[92:93]
    v_cndmask_b32 v108, v108, 7, s[92:93]
    s_add_u32 s67, s67, 1
    v_mov_b32 v111, s67
    v_xor_b32 v12, 16, v0
    v_lshlrev_b32 v12, 22, v12
    v_add_u32 v112, v112, v12
    v_cndmask_b32 v12, v12, 0, s[92:93]
    v_add_u32 v106, v106, v12
    v_mov_b32 v113, 0
    v_mov_b32 v12, 0x4c800000
    v_cndmask_b32 v113, v113, v12, s[92:93]
    s_mov_b32 s46, 0x89000000
    s_mov_b32 s51, 0x20000000
    s_mov_b32 s49, 0x32800000
    s_mov_b32 s50, 0x22800000
    v_cvt_f32_u32 v114, v108
    v_mul_f32 v114, 0xa2800000, v114
    s_mov_b64 s[88:89], 0
    s_mov_b64 s[90:91], 0
    s_mov_b64 s[98:99], s[92:93]
    s_waitcnt vmcnt(28)
    v_perm_b32 v22, v72, v72, v8
    v_perm_b32 v23, v72, v72, v9
    s_nop 1
    v_mfma_f32_16x16x32_bf16 v[56:59], v[22:25], v[200:203], 0
    v_mfma_f32_16x16x32_bf16 v[60:63], v[20:23], v[200:203], 0
    s_waitcnt vmcnt(27)
    v_perm_b32 v26, v72, v72, v10
    v_perm_b32 v27, v72, v72, v11
    s_nop 1
    v_mfma_f32_16x16x32_bf16 v[56:59], v[26:29], v[204:207], v[56:59]
    v_mfma_f32_16x16x32_bf16 v[60:63], v[24:27], v[204:207], v[60:63]
    s_waitcnt vmcnt(26)
    v_perm_b32 v30, v73, v73, v8
    v_perm_b32 v31, v73, v73, v9
    s_nop 1
    v_mfma_f32_16x16x32_bf16 v[56:59], v[30:33], v[208:211], v[56:59]
    v_mfma_f32_16x16x32_bf16 v[60:63], v[28:31], v[208:211], v[60:63]
    s_waitcnt vmcnt(25)
    v_perm_b32 v34, v73, v73, v10
    v_perm_b32 v35, v73, v73, v11
    s_nop 1
    v_mfma_f32_16x16x32_bf16 v[56:59], v[34:37], v[212:215], v[56:59]
    v_mfma_f32_16x16x32_bf16 v[60:63], v[32:35], v[212:215], v[60:63]
    s_waitcnt vmcnt(24)
    v_perm_b32 v22, v74, v74, v8
    v_perm_b32 v23, v74, v74, v9
    s_nop 1
    v_mfma_f32_16x16x32_bf16 v[56:59], v[22:25], v[216:219], v[56:59]
    v_mfma_f32_16x16x32_bf16 v[60:63], v[20:23], v[216:219], v[60:63]
    s_waitcnt vmcnt(23)
    v_perm_b32 v26, v74, v74, v10
    v_perm_b32 v27, v74, v74, v11
    s_nop 1
    v_mfma_f32_16x16x32_bf16 v[56:59], v[26:29], v[220:223], v[56:59]
    v_mfma_f32_16x16x32_bf16 v[60:63], v[24:27], v[220:223], v[60:63]
    s_waitcnt vmcnt(22)
    v_perm_b32 v30, v75, v75, v8
    v_perm_b32 v31, v75, v75, v9
    s_nop 1
    v_mfma_f32_16x16x32_bf16 v[56:59], v[30:33], v[224:227], v[56:59]
    v_mfma_f32_16x16x32_bf16 v[60:63], v[28:31], v[224:227], v[60:63]
    s_waitcnt vmcnt(21)
    v_perm_b32 v34, v75, v75, v10
    v_perm_b32 v35, v75, v75, v11
    s_nop 1
    v_mfma_f32_16x16x32_bf16 v[56:59], v[34:37], v[228:231], v[56:59]
    v_mfma_f32_16x16x32_bf16 v[60:63], v[32:35], v[228:231], v[60:63]
    s_waitcnt vmcnt(20)
    v_perm_b32 v22, v76, v76, v8
    v_perm_b32 v23, v76, v76, v9
    s_nop 1
    v_mfma_f32_16x16x32_bf16 v[56:59], v[22:25], v[232:235], v[56:59]
    v_mfma_f32_16x16x32_bf16 v[60:63], v[20:23], v[232:235], v[60:63]
    s_waitcnt vmcnt(19)
    v_perm_b32 v26, v76, v76, v10
    v_perm_b32 v27, v76, v76, v11
    s_nop 1
    v_mfma_f32_16x16x32_bf16 v[56:59], v[26:29], v[236:239], v[56:59]
    v_mfma_f32_16x16x32_bf16 v[60:63], v[24:27], v[236:239], v[60:63]
    s_waitcnt vmcnt(18)
    v_perm_b32 v30, v77, v77, v8
    v_perm_b32 v31, v77, v77, v9
    s_nop 1
    v_mfma_f32_16x16x32_bf16 v[56:59], v[30:33], v[240:243], v[56:59]
    v_mfma_f32_16x16x32_bf16 v[60:63], v[28:31], v[240:243], v[60:63]
    s_waitcnt vmcnt(17)
    v_perm_b32 v34, v77, v77, v10
    v_perm_b32 v35, v77, v77, v11
    s_nop 1
    v_mfma_f32_16x16x32_bf16 v[56:59], v[34:37], v[244:247], v[56:59]
    v_mfma_f32_16x16x32_bf16 v[60:63], v[32:35], v[244:247], v[60:63]
    s_waitcnt vmcnt(16)
    v_perm_b32 v22, v78, v78, v8
    v_perm_b32 v23, v78, v78, v9
    s_nop 1
    v_mfma_f32_16x16x32_bf16 v[56:59], v[22:25], v[136:139], v[56:59]
    v_mfma_f32_16x16x32_bf16 v[60:63], v[20:23], v[136:139], v[60:63]
    s_waitcnt vmcnt(15)
    v_perm_b32 v26, v78, v78, v10
    v_perm_b32 v27, v78, v78, v11
    s_nop 1
    v_mfma_f32_16x16x32_bf16 v[56:59], v[26:29], v[140:143], v[56:59]
    v_mfma_f32_16x16x32_bf16 v[60:63], v[24:27], v[140:143], v[60:63]
    s_waitcnt vmcnt(14)
    v_perm_b32 v30, v79, v79, v8
    v_perm_b32 v31, v79, v79, v9
    s_nop 1
    v_mfma_f32_16x16x32_bf16 v[56:59], v[30:33], v[144:147], v[56:59]
    v_mfma_f32_16x16x32_bf16 v[60:63], v[28:31], v[144:147], v[60:63]
    s_waitcnt vmcnt(13)
    v_perm_b32 v34, v79, v79, v10
    v_perm_b32 v35, v79, v79, v11
    s_nop 1
    v_mfma_f32_16x16x32_bf16 v[56:59], v[34:37], v[148:151], v[56:59]
    v_mfma_f32_16x16x32_bf16 v[60:63], v[32:35], v[148:151], v[60:63]
    s_waitcnt vmcnt(12)
    v_perm_b32 v22, v80, v80, v8
    v_perm_b32 v23, v80, v80, v9
    s_nop 1
    v_mfma_f32_16x16x32_bf16 v[56:59], v[22:25], v[152:155], v[56:59]
    v_mfma_f32_16x16x32_bf16 v[60:63], v[20:23], v[152:155], v[60:63]
    s_waitcnt vmcnt(11)
    v_perm_b32 v26, v80, v80, v10
    v_perm_b32 v27, v80, v80, v11
    s_nop 1
    v_mfma_f32_16x16x32_bf16 v[56:59], v[26:29], v[156:159], v[56:59]
    v_mfma_f32_16x16x32_bf16 v[60:63], v[24:27], v[156:159], v[60:63]
    s_waitcnt vmcnt(10)
    v_perm_b32 v30, v81, v81, v8
    v_perm_b32 v31, v81, v81, v9
    s_nop 1
    v_mfma_f32_16x16x32_bf16 v[56:59], v[30:33], v[160:163], v[56:59]
    v_mfma_f32_16x16x32_bf16 v[60:63], v[28:31], v[160:163], v[60:63]
    s_waitcnt vmcnt(9)
    v_perm_b32 v34, v81, v81, v10
    v_perm_b32 v35, v81, v81, v11
    s_nop 1
    v_mfma_f32_16x16x32_bf16 v[56:59], v[34:37], v[164:167], v[56:59]
    v_mfma_f32_16x16x32_bf16 v[60:63], v[32:35], v[164:167], v[60:63]
    s_waitcnt vmcnt(8)
    v_perm_b32 v22, v82, v82, v8
    v_perm_b32 v23, v82, v82, v9
    s_nop 1
    v_mfma_f32_16x16x32_bf16 v[56:59], v[22:25], v[168:171], v[56:59]
    v_mfma_f32_16x16x32_bf16 v[60:63], v[20:23], v[168:171], v[60:63]
    s_waitcnt vmcnt(7)
    v_perm_b32 v26, v82, v82, v10
    v_perm_b32 v27, v82, v82, v11
    s_nop 1
    v_mfma_f32_16x16x32_bf16 v[56:59], v[26:29], v[172:175], v[56:59]
    v_mfma_f32_16x16x32_bf16 v[60:63], v[24:27], v[172:175], v[60:63]
    s_waitcnt vmcnt(6)
    v_perm_b32 v30, v83, v83, v8
    v_perm_b32 v31, v83, v83, v9
    s_nop 1
    v_mfma_f32_16x16x32_bf16 v[56:59], v[30:33], v[176:179], v[56:59]
    v_mfma_f32_16x16x32_bf16 v[60:63], v[28:31], v[176:179], v[60:63]
    v_xor_b32 v252, 0x38000, v5
    buffer_load_dwordx4 v[200:203], v252, s[32:35], s62 offen
    s_waitcnt vmcnt(6)
    v_perm_b32 v34, v83, v83, v10
    v_perm_b32 v35, v83, v83, v11
    s_nop 1
    v_mfma_f32_16x16x32_bf16 v[56:59], v[34:37], v[180:183], v[56:59]
    v_mfma_f32_16x16x32_bf16 v[60:63], v[32:35], v[180:183], v[60:63]
    v_xor_b32 v253, 0x3a000, v5
    buffer_load_dwordx4 v[204:207], v253, s[32:35], s62 offen
    s_waitcnt vmcnt(6)
    v_perm_b32 v22, v84, v84, v8
    v_perm_b32 v23, v84, v84, v9
    s_nop 1
    v_mfma_f32_16x16x32_bf16 v[56:59], v[22:25], v[184:187], v[56:59]
    v_mfma_f32_16x16x32_bf16 v[60:63], v[20:23], v[184:187], v[60:63]
    v_xor_b32 v252, 0x3c000, v5
    buffer_load_dwordx4 v[208:211], v252, s[32:35], s62 offen
    s_waitcnt vmcnt(6)
    v_perm_b32 v26, v84, v84, v10
    v_perm_b32 v27, v84, v84, v11
    s_nop 1
    v_mfma_f32_16x16x32_bf16 v[56:59], v[26:29], v[188:191], v[56:59]
    v_mfma_f32_16x16x32_bf16 v[60:63], v[24:27], v[188:191], v[60:63]
    v_xor_b32 v253, 0x3e000, v5
    buffer_load_dwordx4 v[212:215], v253, s[32:35], s62 offen
    s_waitcnt vmcnt(6)
    v_perm_b32 v30, v85, v85, v8
    v_perm_b32 v31, v85, v85, v9
    s_nop 1
    v_mfma_f32_16x16x32_bf16 v[56:59], v[30:33], v[192:195], v[56:59]
    v_mfma_f32_16x16x32_bf16 v[60:63], v[28:31], v[192:195], v[60:63]
    v_xor_b32 v252, 0x40000, v5
    buffer_load_dwordx4 v[216:219], v252, s[32:35], s62 offen
    s_waitcnt vmcnt(6)
    v_perm_b32 v34, v85, v85, v10
    v_perm_b32 v35, v85, v85, v11
    s_nop 1
    v_mfma_f32_16x16x32_bf16 v[56:59], v[34:37], v[196:199], v[56:59]
    v_mfma_f32_16x16x32_bf16 v[60:63], v[32:35], v[196:199], v[60:63]
    v_xor_b32 v253, 0x42000, v5
    buffer_load_dwordx4 v[220:223], v253, s[32:35], s62 offen
    s_waitcnt vmcnt(5)
    v_perm_b32 v22, v86, v86, v8
    v_perm_b32 v23, v86, v86, v9
    s_nop 1
    v_mfma_f32_16x16x32_bf16 v[56:59], v[22:25], v[200:203], v[56:59]
    v_mfma_f32_16x16x32_bf16 v[60:63], v[20:23], v[200:203], v[60:63]
    v_xor_b32 v252, 0x44000, v5
    buffer_load_dwordx4 v[224:227], v252, s[32:35], s62 offen
    s_waitcnt vmcnt(5)
    v_perm_b32 v26, v86, v86, v10
    v_perm_b32 v27, v86, v86, v11
    s_nop 1
    v_mfma_f32_16x16x32_bf16 v[56:59], v[26:29], v[204:207], v[56:59]
    v_mfma_f32_16x16x32_bf16 v[60:63], v[24:27], v[204:207], v[60:63]
    v_xor_b32 v253, 0x46000, v5
    buffer_load_dwordx4 v[228:231], v253, s[32:35], s62 offen
    s_waitcnt vmcnt(5)
    v_perm_b32 v30, v87, v87, v8
    v_perm_b32 v31, v87, v87, v9
    s_nop 1
    v_mfma_f32_16x16x32_bf16 v[56:59], v[30:33], v[208:211], v[56:59]
    v_mfma_f32_16x16x32_bf16 v[60:63], v[28:31], v[208:211], v[60:63]
    v_xor_b32 v252, 0x48000, v5
    buffer_load_dwordx4 v[232:235], v252, s[32:35], s62 offen
    s_waitcnt vmcnt(5)
    v_perm_b32 v34, v87, v87, v10
    v_perm_b32 v35, v87, v87, v11
    s_nop 1
    v_mfma_f32_16x16x32_bf16 v[56:59], v[34:37], v[212:215], v[56:59]
    v_mfma_f32_16x16x32_bf16 v[60:63], v[32:35], v[212:215], v[60:63]
    v_xor_b32 v253, 0x4a000, v5
    buffer_load_dwordx4 v[236:239], v253, s[32:35], s62 offen
    s_waitcnt vmcnt(5)
    v_perm_b32 v22, v88, v88, v8
    v_perm_b32 v23, v88, v88, v9
    s_nop 1
    v_mfma_f32_16x16x32_bf16 v[56:59], v[22:25], v[216:219], v[56:59]
    v_mfma_f32_16x16x32_bf16 v[60:63], v[20:23], v[216:219], v[60:63]
    v_xor_b32 v252, 0x4c000, v5
    buffer_load_dwordx4 v[240:243], v252, s[32:35], s62 offen
    s_waitcnt vmcnt(5)
    v_perm_b32 v26, v88, v88, v10
    v_perm_b32 v27, v88, v88, v11
    s_nop 1
    v_mfma_f32_16x16x32_bf16 v[56:59], v[26:29], v[220:223], v[56:59]
    v_mfma_f32_16x16x32_bf16 v[60:63], v[24:27], v[220:223], v[60:63]
    v_xor_b32 v253, 0x4e000, v5
    buffer_load_dwordx4 v[244:247], v253, s[32:35], s62 offen
    s_waitcnt vmcnt(5)
    v_perm_b32 v30, v89, v89, v8
    v_perm_b32 v31, v89, v89, v9
    s_nop 1
    v_mfma_f32_16x16x32_bf16 v[56:59], v[30:33], v[224:227], v[56:59]
    v_mfma_f32_16x16x32_bf16 v[60:63], v[28:31], v[224:227], v[60:63]
    v_xor_b32 v252, 0x50000, v5
    buffer_load_dwordx4 v[136:139], v252, s[32:35], s62 offen
    s_waitcnt vmcnt(5)
    v_perm_b32 v34, v89, v89, v10
    v_perm_b32 v35, v89, v89, v11
    s_nop 1
    v_mfma_f32_16x16x32_bf16 v[56:59], v[34:37], v[228:231], v[56:59]
    v_mfma_f32_16x16x32_bf16 v[60:63], v[32:35], v[228:231], v[60:63]
    v_xor_b32 v253, 0x52000, v5
    buffer_load_dwordx4 v[140:143], v253, s[32:35], s62 offen
    s_waitcnt vmcnt(5)
    v_perm_b32 v22, v90, v90, v8
    v_perm_b32 v23, v90, v90, v9
    s_nop 1
    v_mfma_f32_16x16x32_bf16 v[56:59], v[22:25], v[232:235], v[56:59]
    v_mfma_f32_16x16x32_bf16 v[60:63], v[20:23], v[232:235], v[60:63]
    v_xor_b32 v252, 0x54000, v5
    buffer_load_dwordx4 v[144:147], v252, s[32:35], s62 offen
    s_waitcnt vmcnt(5)
    v_perm_b32 v26, v90, v90, v10
    v_perm_b32 v27, v90, v90, v11
    s_nop 1
    v_mfma_f32_16x16x32_bf16 v[56:59], v[26:29], v[236:239], v[56:59]
    v_mfma_f32_16x16x32_bf16 v[60:63], v[24:27], v[236:239], v[60:63]
    v_xor_b32 v253, 0x56000, v5
    buffer_load_dwordx4 v[148:151], v253, s[32:35], s62 offen
    s_waitcnt vmcnt(5)
    v_perm_b32 v30, v91, v91, v8
    v_perm_b32 v31, v91, v91, v9
    s_nop 1
    v_mfma_f32_16x16x32_bf16 v[56:59], v[30:33], v[240:243], v[56:59]
    v_mfma_f32_16x16x32_bf16 v[60:63], v[28:31], v[240:243], v[60:63]
    v_xor_b32 v252, 0x58000, v5
    buffer_load_dwordx4 v[152:155], v252, s[32:35], s62 offen
    s_waitcnt vmcnt(5)
    v_perm_b32 v34, v91, v91, v10
    v_perm_b32 v35, v91, v91, v11
    s_nop 1
    v_mfma_f32_16x16x32_bf16 v[56:59], v[34:37], v[244:247], v[56:59]
    v_mfma_f32_16x16x32_bf16 v[60:63], v[32:35], v[244:247], v[60:63]
    v_xor_b32 v253, 0x5a000, v5
    buffer_load_dwordx4 v[156:159], v253, s[32:35], s62 offen
    s_waitcnt vmcnt(5)
    v_perm_b32 v22, v92, v92, v8
    v_perm_b32 v23, v92, v92, v9
    s_nop 1
    v_mfma_f32_16x16x32_bf16 v[56:59], v[22:25], v[136:139], v[56:59]
    v_mfma_f32_16x16x32_bf16 v[60:63], v[20:23], v[136:139], v[60:63]
    v_xor_b32 v252, 0x5c000, v5
    buffer_load_dwordx4 v[160:163], v252, s[32:35], s62 offen
    s_waitcnt vmcnt(5)
    v_perm_b32 v26, v92, v92, v10
    v_perm_b32 v27, v92, v92, v11
    s_nop 1
    v_mfma_f32_16x16x32_bf16 v[56:59], v[26:29], v[140:143], v[56:59]
    v_mfma_f32_16x16x32_bf16 v[60:63], v[24:27], v[140:143], v[60:63]
    v_xor_b32 v253, 0x5e000, v5
    buffer_load_dwordx4 v[164:167], v253, s[32:35], s62 offen
    s_waitcnt vmcnt(5)
    v_perm_b32 v30, v93, v93, v8
    v_perm_b32 v31, v93, v93, v9
    s_nop 1
    v_mfma_f32_16x16x32_bf16 v[56:59], v[30:33], v[144:147], v[56:59]
    v_mfma_f32_16x16x32_bf16 v[60:63], v[28:31], v[144:147], v[60:63]
    v_xor_b32 v252, 0x60000, v5
    buffer_load_dwordx4 v[168:171], v252, s[32:35], s62 offen
    s_waitcnt vmcnt(5)
    v_perm_b32 v34, v93, v93, v10
    v_perm_b32 v35, v93, v93, v11
    s_nop 1
    v_mfma_f32_16x16x32_bf16 v[56:59], v[34:37], v[148:151], v[56:59]
    v_mfma_f32_16x16x32_bf16 v[60:63], v[32:35], v[148:151], v[60:63]
    v_xor_b32 v253, 0x62000, v5
    buffer_load_dwordx4 v[172:175], v253, s[32:35], s62 offen
    s_waitcnt vmcnt(5)
    v_perm_b32 v22, v94, v94, v8
    v_perm_b32 v23, v94, v94, v9
    s_nop 1
    v_mfma_f32_16x16x32_bf16 v[56:59], v[22:25], v[152:155], v[56:59]
    v_mfma_f32_16x16x32_bf16 v[60:63], v[20:23], v[152:155], v[60:63]
    v_xor_b32 v252, 0x64000, v5
    buffer_load_dwordx4 v[176:179], v252, s[32:35], s62 offen
    s_waitcnt vmcnt(5)
    v_perm_b32 v26, v94, v94, v10
    v_perm_b32 v27, v94, v94, v11
    s_nop 1
    v_mfma_f32_16x16x32_bf16 v[56:59], v[26:29], v[156:159], v[56:59]
    v_mfma_f32_16x16x32_bf16 v[60:63], v[24:27], v[156:159], v[60:63]
    v_xor_b32 v253, 0x66000, v5
    buffer_load_dwordx4 v[180:183], v253, s[32:35], s62 offen
    s_waitcnt vmcnt(5)
    v_perm_b32 v30, v95, v95, v8
    v_perm_b32 v31, v95, v95, v9
    s_nop 1
    v_mfma_f32_16x16x32_bf16 v[56:59], v[30:33], v[160:163], v[56:59]
    v_mfma_f32_16x16x32_bf16 v[60:63], v[28:31], v[160:163], v[60:63]
    v_xor_b32 v252, 0x68000, v5
    buffer_load_dwordx4 v[184:187], v252, s[32:35], s62 offen
    s_waitcnt vmcnt(5)
    v_perm_b32 v34, v95, v95, v10
    v_perm_b32 v35, v95, v95, v11
    s_nop 1
    v_mfma_f32_16x16x32_bf16 v[56:59], v[34:37], v[164:167], v[56:59]
    v_mfma_f32_16x16x32_bf16 v[60:63], v[32:35], v[164:167], v[60:63]
    v_xor_b32 v253, 0x6a000, v5
    buffer_load_dwordx4 v[188:191], v253, s[32:35], s62 offen
    s_waitcnt vmcnt(5)
    v_perm_b32 v22, v96, v96, v8
    v_perm_b32 v23, v96, v96, v9
    s_nop 1
    v_mfma_f32_16x16x32_bf16 v[56:59], v[22:25], v[168:171], v[56:59]
    v_mfma_f32_16x16x32_bf16 v[60:63], v[20:23], v[168:171], v[60:63]
    v_xor_b32 v252, 0x6c000, v5
    buffer_load_dwordx4 v[192:195], v252, s[32:35], s62 offen
    s_waitcnt vmcnt(5)
    v_perm_b32 v26, v96, v96, v10
    v_perm_b32 v27, v96, v96, v11
    s_nop 1
    v_mfma_f32_16x16x32_bf16 v[56:59], v[26:29], v[172:175], v[56:59]
    v_mfma_f32_16x16x32_bf16 v[60:63], v[24:27], v[172:175], v[60:63]
    v_xor_b32 v253, 0x6e000, v5
    buffer_load_dwordx4 v[196:199], v253, s[32:35], s62 offen
    s_waitcnt vmcnt(5)
    v_perm_b32 v30, v97, v97, v8
    v_perm_b32 v31, v97, v97, v9
    s_nop 1
    v_mfma_f32_16x16x32_bf16 v[56:59], v[30:33], v[176:179], v[56:59]
    v_mfma_f32_16x16x32_bf16 v[60:63], v[28:31], v[176:179], v[60:63]
    v_xor_b32 v252, 0x70000, v5
    buffer_load_dwordx4 v[200:203], v252, s[32:35], s62 offen
    s_waitcnt vmcnt(5)
    v_perm_b32 v34, v97, v97, v10
    v_perm_b32 v35, v97, v97, v11
    s_nop 1
    v_mfma_f32_16x16x32_bf16 v[56:59], v[34:37], v[180:183], v[56:59]
    v_mfma_f32_16x16x32_bf16 v[60:63], v[32:35], v[180:183], v[60:63]
    v_xor_b32 v253, 0x72000, v5
    buffer_load_dwordx4 v[204:207], v253, s[32:35], s62 offen
    s_waitcnt vmcnt(5)
    v_perm_b32 v22, v98, v98, v8
    v_perm_b32 v23, v98, v98, v9
    s_nop 1
    v_mfma_f32_16x16x32_bf16 v[56:59], v[22:25], v[184:187], v[56:59]
    v_mfma_f32_16x16x32_bf16 v[60:63], v[20:23], v[184:187], v[60:63]
    v_xor_b32 v252, 0x74000, v5
    buffer_load_dwordx4 v[208:211], v252, s[32:35], s62 offen
    s_waitcnt vmcnt(5)
    v_perm_b32 v26, v98, v98, v10
    v_perm_b32 v27, v98, v98, v11
    s_nop 1
    v_mfma_f32_16x16x32_bf16 v[56:59], v[26:29], v[188:191], v[56:59]
    v_mfma_f32_16x16x32_bf16 v[60:63], v[24:27], v[188:191], v[60:63]
    v_xor_b32 v253, 0x76000, v5
    buffer_load_dwordx4 v[212:215], v253, s[32:35], s62 offen
    s_waitcnt vmcnt(5)
    v_perm_b32 v30, v99, v99, v8
    v_perm_b32 v31, v99, v99, v9
    s_nop 1
    v_mfma_f32_16x16x32_bf16 v[56:59], v[30:33], v[192:195], v[56:59]
    v_mfma_f32_16x16x32_bf16 v[60:63], v[28:31], v[192:195], v[60:63]
    v_xor_b32 v252, 0x78000, v5
    buffer_load_dwordx4 v[216:219], v252, s[32:35], s62 offen
    s_waitcnt vmcnt(5)
    v_perm_b32 v34, v99, v99, v10
    v_perm_b32 v35, v99, v99, v11
    s_nop 1
    v_mfma_f32_16x16x32_bf16 v[56:59], v[34:37], v[196:199], v[56:59]
    v_mfma_f32_16x16x32_bf16 v[60:63], v[32:35], v[196:199], v[60:63]
    v_xor_b32 v253, 0x7a000, v5
    buffer_load_dwordx4 v[220:223], v253, s[32:35], s62 offen
    s_waitcnt vmcnt(5)
    v_perm_b32 v22, v100, v100, v8
    v_perm_b32 v23, v100, v100, v9
    s_nop 1
    v_mfma_f32_16x16x32_bf16 v[56:59], v[22:25], v[200:203], v[56:59]
    v_mfma_f32_16x16x32_bf16 v[60:63], v[20:23], v[200:203], v[60:63]
    v_xor_b32 v252, 0x7c000, v5
    buffer_load_dwordx4 v[224:227], v252, s[32:35], s62 offen
    s_waitcnt vmcnt(5)
    v_perm_b32 v26, v100, v100, v10
    v_perm_b32 v27, v100, v100, v11
    s_nop 1
    v_mfma_f32_16x16x32_bf16 v[56:59], v[26:29], v[204:207], v[56:59]
    v_mfma_f32_16x16x32_bf16 v[60:63], v[24:27], v[204:207], v[60:63]
    v_xor_b32 v253, 0x7e000, v5
    buffer_load_dwordx4 v[228:231], v253, s[32:35], s62 offen
    s_waitcnt vmcnt(5)
    v_perm_b32 v30, v101, v101, v8
    v_perm_b32 v31, v101, v101, v9
    s_nop 1
    v_mfma_f32_16x16x32_bf16 v[56:59], v[30:33], v[208:211], v[56:59]
    v_mfma_f32_16x16x32_bf16 v[60:63], v[28:31], v[208:211], v[60:63]
    s_waitcnt vmcnt(4)
    v_perm_b32 v34, v101, v101, v10
    v_perm_b32 v35, v101, v101, v11
    s_nop 1
    v_mfma_f32_16x16x32_bf16 v[56:59], v[34:37], v[212:215], v[56:59]
    v_mfma_f32_16x16x32_bf16 v[60:63], v[32:35], v[212:215], v[60:63]
    s_waitcnt vmcnt(3)
    v_perm_b32 v22, v102, v102, v8
    v_perm_b32 v23, v102, v102, v9
    s_nop 1
    v_mfma_f32_16x16x32_bf16 v[56:59], v[22:25], v[216:219], v[56:59]
    v_mfma_f32_16x16x32_bf16 v[60:63], v[20:23], v[216:219], v[60:63]
    s_waitcnt vmcnt(2)
    v_perm_b32 v26, v102, v102, v10
    v_perm_b32 v27, v102, v102, v11
    s_nop 1
    v_mfma_f32_16x16x32_bf16 v[56:59], v[26:29], v[220:223], v[56:59]
    v_mfma_f32_16x16x32_bf16 v[60:63], v[24:27], v[220:223], v[60:63]
    s_waitcnt vmcnt(1)
    v_perm_b32 v30, v103, v103, v8
    v_perm_b32 v31, v103, v103, v9
    s_nop 1
    v_mfma_f32_16x16x32_bf16 v[56:59], v[30:33], v[224:227], v[56:59]
    v_mfma_f32_16x16x32_bf16 v[60:63], v[28:31], v[224:227], v[60:63]
    s_waitcnt vmcnt(0)
    v_perm_b32 v34, v103, v103, v10
    v_perm_b32 v35, v103, v103, v11
    s_nop 1
    v_mfma_f32_16x16x32_bf16 v[56:59], v[34:37], v[228:231], v[56:59]
    v_mfma_f32_16x16x32_bf16 v[60:63], v[32:35], v[228:231], v[60:63]
    s_nop 7
    v_permlane32_swap_b32 v56, v60
    v_permlane32_swap_b32 v57, v61
    v_permlane32_swap_b32 v58, v62
    v_permlane32_swap_b32 v59, v63
    v_add_f32_dpp v64, v60, v56 row_ror:8 row_mask:0xf bank_mask:0x3
    v_add_f32_dpp v66, v61, v57 row_ror:8 row_mask:0xf bank_mask:0x3
    s_nop 0
    v_add_f32_dpp v64, v58, v62 row_ror:8 row_mask:0xf bank_mask:0xc
    v_add_f32_dpp v66, v59, v63 row_ror:8 row_mask:0xf bank_mask:0xc
    s_mov_b32 s62, s63
    s_mov_b32 s52, s54
    s_mov_b32 s84, 400000
L_chkB:
    v_cmp_ne_u32 vcc, s68, v116
    s_cbranch_vccnz L_retryB
L_okB:
    v_mul_legacy_f32 v124, v64, v113
    v_mul_legacy_f32 v125, v66, v113
    v_fract_f32 v120, v124
    v_fract_f32 v122, v125
    v_lshl_add_u32 v130, v124, 1, s46
    v_lshl_add_u32 v131, v125, 1, s46
    v_mul_f32 v120, 0x4f800000, v120
    v_mul_f32 v122, 0x4f800000, v122
    v_max_u32 v128, v130, v131
    v_cvt_u32_f32 v120, v120
    v_cvt_u32_f32 v122, v122
    v_cmp_le_u32 vcc, s51, v128
    v_cvt_flr_i32_f32 v121, v124
    v_cvt_flr_i32_f32 v123, v125
    s_and_b64 vcc, vcc, s[98:99]
    v_and_or_b32 v120, v120, s47, 1
    v_and_or_b32 v122, v122, s47, 1
    s_cbranch_scc1 L_excB
L_addB:
    buffer_atomic_add_x2 v[120:121], v106, s[36:39], s64 offen offset:0 sc0 sc1
    buffer_atomic_add_x2 v[122:123], v106, s[36:39], s64 offen offset:256 sc0 sc1
    v_fma_f32 v130, v124, s49, v114
    v_fma_f32 v131, v125, s49, v114
    s_waitcnt vmcnt(0)
    v_cvt_f32_u32 v126, v120
    v_cvt_f32_u32 v127, v122
    v_cvt_f32_i32 v128, v121
    v_cvt_f32_i32 v129, v123
    v_and_b32 v132, 0x7f, v120
    v_and_b32 v133, 0x7f, v122
    v_fma_f32 v126, v126, s50, v130
    v_fma_f32 v127, v127, s50, v131
    v_cmp_eq_u32 s[92:93], v132, v108
    v_cmp_eq_u32 s[94:95], v133, v108
    v_fma_f32 v126, v128, s49, v126
    v_fma_f32 v127, v129, s49, v127
    s_and_b64 vcc, s[92:93], s[94:95]
    v_cvt_pk_bf16_f32 v130, v126, v127
    v_cndmask_b32 v132, v115, v107, vcc
    buffer_store_dword v130, v132, s[16:19], s52 offen sc1
    v_cndmask_b32 v112, v115, v112, s[92:93]
    buffer_store_dword v111, v112, s[36:39], 0 offen sc1
    v_and_b32 v126, 0x3f80, v120
    v_and_b32 v127, 0x3f80, v122
    v_cmp_ne_u32 vcc, 0, v126
    v_cmp_ne_u32 s[96:97], 0, v127
    s_xor_b64 s[86:87], s[92:93], s[94:95]
    s_or_b64 vcc, vcc, s[88:89]
    s_or_b64 s[96:97], s[96:97], s[90:91]
    s_and_b64 vcc, vcc, s[92:93]
    s_and_b64 s[96:97], s[96:97], s[94:95]
    s_or_b64 s[96:97], s[96:97], vcc
    s_or_b64 s[86:87], s[86:87], s[96:97]
    s_cbranch_scc1 L_finB
L_endB:
    s_endpgm
L_initB:
    s_mov_b32 s36, s14
    s_and_b32 s37, s15, 0xffff
    s_mov_b32 s38, 0x200000
    s_mov_b32 s39, 0x00020000
    s_lshl_b32 s66, s40, 2
    s_add_u32 s66, s66, 1581056
    s_load_dword s67, s[14:15], s66
    s_lshl_b32 s46, s40, 3
    s_add_u32 s46, s46, s41
    s_mov_b32 s47, 0x1b0000
    s_bfe_u32 s48, s41, 0x30000
    s_lshl_b32 s48, s48, 9
    s_or_b32 s47, s47, s48
    s_bfe_u32 s48, s40, 0x20000
    s_lshl_b32 s48, s48, 12
    s_or_b32 s47, s47, s48
    s_lshl_b32 s46, s46, 7
    s_add_u32 s46, s46, 1585152
    v_mov_b32 v72, 0
    v_mov_b32 v73, 0
    v_mov_b32 v74, 0
    v_mov_b32 v75, 0
    v_mov_b32 v76, 0
    v_bfe_u32 v77, v1, 0, 5
    v_lshl_or_b32 v76, v77, 4, v76
    v_bfe_u32 v77, v1, 5, 1
    v_lshl_or_b32 v76, v77, 14, v76
    buffer_store_dwordx4 v[72:75], v76, s[36:39], s47 offen sc1
    s_add_u32 s47, s47, 0x8000
    buffer_store_dwordx4 v[72:75], v76, s[36:39], s47 offen sc1
    v_lshrrev_b32 v77, 5, v1
    v_lshlrev_b32 v77, 24, v77
    v_lshl_add_u32 v76, v1, 2, v77
    s_waitcnt vmcnt(0) lgkmcnt(0)
    s_mul_i32 s68, s67, 0x9e3779b1
    s_add_u32 s68, s68, 0x7f4a7c15
    v_mov_b32 v77, s68
    buffer_store_dword v77, v76, s[36:39], s46 offen sc1
    s_nop 4
    s_branch L_initB_ret
L_retryB:
    buffer_load_dword v116, v117, s[36:39], s48 offen sc1
    s_waitcnt vmcnt(0)
    s_sub_u32 s84, s84, 1
    s_cbranch_scc0 L_chkB
    s_branch L_okB
L_excB:
    s_nop 7
    v_cmp_le_u32 s[88:89], s51, v130
    v_cmp_le_u32 s[90:91], s51, v131
    v_cmp_ne_u32 s[92:93], s46, v130
    v_cmp_ne_u32 s[94:95], s46, v131
    v_mul_f32 v128, s49, v113
    v_mov_b32 v129, 0x81
    s_and_b64 s[88:89], s[88:89], s[98:99]
    s_and_b64 s[90:91], s[90:91], s[98:99]
    s_and_b64 s[88:89], s[88:89], s[92:93]
    s_and_b64 s[90:91], s[90:91], s[94:95]
    s_or_b64 s[96:97], s[88:89], s[90:91]
    s_cbranch_scc0 L_addB
    v_mul_legacy_f32 v130, v64, v128
    v_mul_legacy_f32 v131, v66, v128
    v_cndmask_b32 v132, v115, v106, s[88:89]
    v_cndmask_b32 v133, v115, v106, s[90:91]
    s_add_u32 s84, s64, 0x8000
    buffer_atomic_add_f32 v130, v132, s[36:39], s84 offen offset:0 sc1
    buffer_atomic_add_f32 v131, v133, s[36:39], s84 offen offset:256 sc1
    v_cndmask_b32 v120, v120, v129, s[88:89]
    v_cndmask_b32 v121, v121, 0, s[88:89]
    v_cndmask_b32 v124, v124, 0, s[88:89]
    v_cndmask_b32 v122, v122, v129, s[90:91]
    v_cndmask_b32 v123, v123, 0, s[90:91]
    v_cndmask_b32 v125, v125, 0, s[90:91]
    s_waitcnt vmcnt(0)
    s_branch L_addB
L_finB:
    s_nop 7
    v_cndmask_b32 v132, v115, v107, s[92:93]
    v_cndmask_b32 v133, v115, v107, s[94:95]
    buffer_store_short v130, v132, s[16:19], s52 offen sc1
    buffer_store_short_d16_hi v130, v133, s[16:19], s52 offen offset:2 sc1
    s_cmp_eq_u64 s[96:97], 0
    s_cbranch_scc1 L_endB
    s_add_u32 s84, s64, 0x8000
    buffer_load_dword v64, v106, s[36:39], s84 offen offset:0 sc1
    buffer_load_dword v66, v106, s[36:39], s84 offen offset:256 sc1
    v_and_b32 v126, s47, v120
    v_and_b32 v127, s47, v122
    v_cvt_f32_u32 v126, v126
    v_cvt_f32_u32 v127, v127
    v_mul_f32 v124, s49, v124
    v_mul_f32 v125, s49, v125
    v_fma_f32 v126, v126, s50, v124
    v_fma_f32 v127, v127, s50, v125
    v_fma_f32 v126, v128, s49, v126
    v_fma_f32 v127, v129, s49, v127
    s_waitcnt vmcnt(0)
    v_add_f32 v126, v126, v64
    v_add_f32 v127, v127, v66
    v_cndmask_b32 v132, v115, v107, s[92:93]
    v_cndmask_b32 v133, v115, v107, s[94:95]
    v_cvt_pk_bf16_f32 v130, v126, v127
    buffer_store_short v130, v132, s[16:19], s52 offen sc1
    buffer_store_short_d16_hi v130, v133, s[16:19], s52 offen offset:2 sc1
    s_branch L_endB
.section .rodata,"a"
.p2align 6
.amdhsa_kernel concat_heads__mha_block_cached__sliding_block_cached__decode_kernel
  .amdhsa_next_free_vgpr 256
  .amdhsa_next_free_sgpr 100
  .amdhsa_accum_offset 256
  .amdhsa_group_segment_fixed_size 0
  .amdhsa_kernarg_size 104
  .amdhsa_user_sgpr_count 2
  .amdhsa_user_sgpr_kernarg_segment_ptr 1
  .amdhsa_system_sgpr_workgroup_id_x 1
.end_amdhsa_kernel
```
